```python
import torch

def _softmax(x, axis=-1):
    return torch.softmax(x, dim=axis)
def _gelu(x):
    return torch.nn.functional.gelu(x, approximate="tanh")
def _silu(x):
    return torch.nn.functional.silu(x)
def _sigmoid(x):
    return torch.sigmoid(x)
def _layernorm(x, axis=-1, eps=1e-5):
    m = x.mean(dim=axis, keepdim=True)
    v = x.var(dim=axis, keepdim=True, unbiased=False)
    return (x - m) / torch.sqrt(v + eps)
def _scatter_add(tgt, idx, src, axis=0):
    return tgt.clone().index_add_(axis, idx, src)
def _segment_sum(src, seg, n):
    out = torch.zeros((n,) + src.shape[1:], dtype=src.dtype)
    return out.index_add_(0, seg, src)
def _pad(x, pw):
    flat = tuple(v for pair in reversed(pw) for v in pair)
    return torch.nn.functional.pad(x, flat)

kernel_name = 'parallel_sum__sliding_block__glu_gated_geglu__prompt'

def setup_inputs():

    _w = (lambda a: (lambda t: t.to(torch.bfloat16) if t.is_floating_point() else t)(torch.as_tensor(a)))
    def _A_setup():
        B, S, D = 1, 2048, 512
        return {
            "x": _w((lambda *s: torch.randn(*s, dtype=torch.bfloat16) * 0.05)(B, S, D)),
            "wqkv": _w((lambda *s: torch.randn(*s, dtype=torch.bfloat16) * 0.05)(D, 3 * D)),
            "wo": _w((lambda *s: torch.randn(*s, dtype=torch.bfloat16) * 0.05)(D, D)),
        }
    _A_in = _A_setup()

    def _B_setup():
        B, S, Dm, Df = 1, 2048, 512, 1376
        return {
            "x": _w((lambda *s: torch.randn(*s, dtype=torch.bfloat16) * 0.05)(B, S, Dm)),
            "w_gate": _w((lambda *s: torch.randn(*s, dtype=torch.bfloat16) * 0.8)(Dm, Df) * (Dm ** -0.5)),
            "w_up": _w((lambda *s: torch.randn(*s, dtype=torch.bfloat16) * 0.8)(Dm, Df) * (Dm ** -0.5)),
            "w_down": _w((lambda *s: torch.randn(*s, dtype=torch.bfloat16) * 0.8)(Df, Dm) * (Df ** -0.5)),
        }
    _B_in = _B_setup()

    return {
        "A_x": _A_in["x"],
        "A_wqkv": _A_in["wqkv"],
        "A_wo": _A_in["wo"],
        "B_x": _B_in["x"],
        "B_w_gate": _B_in["w_gate"],
        "B_w_up": _B_in["w_up"],
        "B_w_down": _B_in["w_down"],
    }

def reference(A_x, A_wqkv, A_wo, B_x, B_w_gate, B_w_up, B_w_down):
    def _A_ref(x, wqkv, wo):
        B, S, D = x.shape
        H = 32; Dh = D // H; W = 256
        qkv = (lambda x, *d: x.permute(*d))((x @ wqkv).reshape(B, S, 3, H, Dh), 2, 0, 3, 1, 4)
        q, k, v = qkv[0], qkv[1], qkv[2]
        scores = torch.einsum("bhqd,bhkd->bhqk", q, k) * (Dh ** -0.5)
        idx = torch.arange(S)
        mask = (idx[:, None] - idx[None, :] >= 0) & (idx[:, None] - idx[None, :] < W)
        scores = torch.where(mask[None, None], scores, -1e9)
        p = _softmax(scores, axis=-1)
        o = torch.einsum("bhqk,bhkd->bhqd", p, v)
        return (lambda x, *d: x.permute(*d))(o, 0, 2, 1, 3).reshape(B, S, D) @ wo

    def _B_ref(x, w_gate, w_up, w_down):
        g = torch.einsum("bsd,df->bsf", x, w_gate)
        u = torch.einsum("bsd,df->bsf", x, w_up)
        h = _gelu(g) * u
        return torch.einsum("bsf,fd->bsd", h, w_down)

    x = A_x
    xn = _layernorm(x, axis=-1)
    return x + _A_ref(xn, A_wqkv, A_wo) + _B_ref(xn, B_w_gate, B_w_up, B_w_down)
```

```asm
; @launch grid=(256,1,1) block=(256,1,1) lds=163840
.amdgcn_target "amdgcn-amd-amdhsa--gfx950"
.text
.globl parallel_sum__sliding_block__glu_gated_geglu__prompt_kernel
.p2align 8
.type parallel_sum__sliding_block__glu_gated_geglu__prompt_kernel,@function
parallel_sum__sliding_block__glu_gated_geglu__prompt_kernel:
    s_cmp_ge_u32 s2, 256
    s_cbranch_scc1 L_end
    s_load_dwordx2 s[24:25], s[0:1], 0
    s_load_dwordx2 s[28:29], s[0:1], 8
    s_load_dwordx2 s[32:33], s[0:1], 32
    s_load_dwordx2 s[36:37], s[0:1], 40
    s_getpc_b64 s[40:41]
    s_lshr_b32 s74, s2, 3
    s_lshl_b32 s44, s74, 10
    s_add_u32 s42, s44, 1024
    s_mov_b32 s43, 0x20000
    v_lshlrev_b32 v2, 7, v0
    buffer_load_dword v255, v2, s[40:43], s44 offen
    v_lshrrev_b32 v1, 6, v0
    v_and_b32 v0, 63, v0
    v_readfirstlane_b32 s3, v1
    s_bfe_u32 s73, s2, 0x10002
    s_and_b32 s76, s74, 7
    s_lshl3_add_u32 s60, s73, s76
    s_and_b32 s73, s2, 3
    s_lshr_b32 s76, s2, 6
    s_lshl2_add_u32 s61, s73, s76
    s_add_u32 s85, s61, s60
    s_and_b32 s85, s85, 3
    s_lshl_b32 s68, s85, 8
    s_mul_i32 s69, s85, 393216
    s_mul_i32 s70, s85, 352256
    s_lshl2_add_u32 s67, s60, s3
    s_lshl_b32 s73, s67, 15
    s_lshl_b32 s71, s3, 12
    s_lshl_b32 s72, s3, 11
    s_bitset1_b32 s72, 16
    v_lshrrev_b32 v1, 3, v0
    v_lshl_add_u32 v1, v1, 10, s73
    v_and_b32 v2, 7, v0
    v_lshrrev_b32 v3, 4, v0
    v_xor_b32 v2, v2, v3
    v_lshl_add_u32 v4, v2, 4, v1
    v_xor_b32 v5, 64, v4
    v_add_u32 v5, 7168, v5
    v_add_u32 v6, 14336, v4
    v_add_u32 v7, 14336, v5
    s_lshl_b32 s73, s61, 1
    s_lshr_b32 s73, 0x3aaa4000, s73
    s_and_b32 s73, s73, 3
    s_mul_i32 s64, s61, 3
    s_sub_u32 s64, s64, s73
    s_min_u32 s64, s64, 41
    v_lshrrev_b32 v1, 5, v0
    v_bfe_u32 v2, v0, 2, 2
    v_lshl_add_u32 v1, v1, 2, v2
    v_and_b32 v2, 16, v0
    v_and_b32 v3, 3, v0
    v_lshl_add_u32 v2, v3, 2, v2
    v_lshlrev_b32 v2, 2, v2
    v_lshl_add_u32 v62, v1, 10, v2
    s_lshl_b32 s73, s3, 4
    v_add_u32 v1, s73, v1
    s_and_b32 s73, s61, 1
    s_lshr_b32 s76, s61, 1
    s_lshl3_add_u32 s73, s73, s76
    s_add_u32 s73, s73, 8
    s_lshl_b32 s73, s73, 7
    s_movk_i32 s76, 3072
    v_mad_u32_u24 v8, v1, s76, v2
    v_add_u32 v8, s73, v8
    v_add_u32 v9, 23552, v8
    s_lshl_b32 s73, s64, 6
    s_movk_i32 s76, 2752
    v_mad_u32_u24 v10, v1, s76, v2
    v_add_u32 v10, s73, v10
    v_add_u32 v11, 20992, v10
    s_mov_b32 s26, 2097152
    s_mov_b32 s27, 0x20000
    s_mov_b32 s30, 1572864
    s_mov_b32 s31, s27
    s_mov_b32 s34, 1409024
    s_mov_b32 s35, s27
    s_mov_b32 s38, s34
    s_mov_b32 s39, s27
    s_mov_b32 m0, s71
    s_waitcnt lgkmcnt(0)
    buffer_load_dwordx4 v4, s[24:27], s68 offen  lds
    buffer_load_dwordx4 v5, s[24:27], s68 offen offset:1024  lds
    buffer_load_dwordx4 v6, s[24:27], s68 offen offset:2048  lds
    buffer_load_dwordx4 v7, s[24:27], s68 offen offset:3072  lds
    s_mov_b32 m0, s72
    s_nop 0
    buffer_load_dwordx4 v8, s[28:31], s69 offen  lds
    buffer_load_dwordx4 v9, s[28:31], s69 offen offset:1024  lds
    s_add_u32 m0, s72, 8192
    s_nop 0
    buffer_load_dwordx4 v10, s[32:35], s70 offen  lds
    buffer_load_dwordx4 v11, s[32:35], s70 offen offset:1024  lds
    s_add_u32 m0, s72, 16384
    s_nop 0
    buffer_load_dwordx4 v10, s[36:39], s70 offen  lds
    s_load_dwordx2 s[8:9], s[0:1], 16
    s_load_dwordx4 s[16:19], s[0:1], 48
    s_load_dwordx4 s[20:23], s[0:1], 64
    s_and_b32 s73, s2, 7
    s_and_b32 s76, s74, 3
    s_lshl2_add_u32 s62, s73, s76
    s_lshr_b32 s63, s74, 2
    s_mov_b32 s83, 0x76543210
    s_cmp_eq_u32 s85, 1
    s_cselect_b32 s83, 0x10765432, s83
    s_cmp_eq_u32 s85, 2
    s_cselect_b32 s83, 0x32107654, s83
    s_cmp_eq_u32 s85, 3
    s_cselect_b32 s83, 0x54321076, s83
    s_waitcnt lgkmcnt(0)
    s_mov_b32 s52, s22
    s_mov_b32 s53, s23
    s_mov_b32 s54, 13631488
    s_mov_b32 s55, 0x20000
    s_mov_b32 s56, s20
    s_mov_b32 s57, s21
    s_mov_b32 s58, 256
    s_mov_b32 s59, 0x20000
    s_mov_b32 s86, 1073741824
    v_lshlrev_b32 v52, 4, v0
    s_cmp_eq_u32 s2, 0
    s_cbranch_scc1 L_zero
L_zero_done:
    s_mov_b32 s40, s16
    s_mov_b32 s41, s17
    s_mov_b32 s42, 1409024
    s_mov_b32 s43, 0x20000
    s_mov_b32 s44, s8
    s_mov_b32 s45, s9
    s_mov_b32 s46, 524288
    s_mov_b32 s47, 0x20000
    s_mov_b32 s48, s18
    s_mov_b32 s49, s19
    s_mov_b32 s50, 2097152
    s_mov_b32 s51, 0x20000
    s_lshr_b32 s84, s3, 1
    s_lshl_b32 s84, s84, 2
    s_lshr_b32 s84, s83, s84
    s_lshr_b32 s73, 0xe0c0, s61
    s_and_b32 s73, s73, 1
    s_cselect_b32 s16, s86, 0
    s_add_u32 s65, s64, 2
    v_and_b32 v1, 31, v0
    v_lshrrev_b32 v2, 5, v0
    v_bfe_u32 v3, v0, 1, 3
    v_xor_b32 v3, v3, v2
    v_lshlrev_b32 v1, 7, v1
    v_lshl_add_u32 v1, v3, 4, v1
    v_add_u32 v1, s71, v1
    s_xor_b32 s73, s3, 0
    s_lshl_b32 s73, s73, 5
    v_xor_b32 v12, s73, v1
    v_xor_b32 v16, 4096, v12
    s_xor_b32 s73, s3, 1
    s_lshl_b32 s73, s73, 5
    v_xor_b32 v13, s73, v1
    v_xor_b32 v17, 4096, v13
    s_xor_b32 s73, s3, 2
    s_lshl_b32 s73, s73, 5
    v_xor_b32 v14, s73, v1
    v_xor_b32 v18, 4096, v14
    s_xor_b32 s73, s3, 3
    s_lshl_b32 s73, s73, 5
    v_xor_b32 v15, s73, v1
    v_xor_b32 v19, 4096, v15
    v_bfe_u32 v3, v0, 2, 2
    v_lshlrev_b32 v3, 6, v3
    v_bfe_u32 v1, v0, 4, 1
    v_lshl_add_u32 v3, v1, 5, v3
    v_and_b32 v1, 3, v0
    v_lshl_add_u32 v3, v1, 3, v3
    v_lshl_add_u32 v1, v2, 10, v3
    v_lshl_add_u32 v3, v2, 9, v3
    s_and_b32 s75, s3, 1
    s_lshl_b32 s75, s75, 8
    s_add_u32 s75, s75, 65536
    s_mul_i32 s73, s3, 6144
    s_add_u32 s80, s73, 65536
    v_add_u32 v2, s80, v3
    v_mov_b32 v215, v2
    v_add_u32 v2, 49152, v2
    v_mov_b32 v216, v2
    s_xor_b32 s73, s3, 0
    s_lshl_b32 s74, s73, 11
    s_add_u32 s74, s74, s75
    v_add_u32 v20, s74, v1
    v_add_u32 v21, 49152, v20
    s_lshl_b32 s74, s73, 10
    s_add_u32 s74, s74, 65536
    v_add_u32 v32, s74, v3
    v_add_u32 v33, 49152, v32
    s_xor_b32 s73, s3, 1
    s_lshl_b32 s74, s73, 11
    s_add_u32 s74, s74, s75
    v_add_u32 v22, s74, v1
    v_add_u32 v23, 49152, v22
    s_lshl_b32 s74, s73, 10
    s_add_u32 s74, s74, 65536
    v_add_u32 v34, s74, v3
    v_add_u32 v35, 49152, v34
    s_xor_b32 s73, s3, 2
    s_lshl_b32 s74, s73, 11
    s_add_u32 s74, s74, s75
    v_add_u32 v24, s74, v1
    v_add_u32 v25, 49152, v24
    s_lshl_b32 s74, s73, 10
    s_add_u32 s74, s74, 65536
    v_add_u32 v36, s74, v3
    v_add_u32 v37, 49152, v36
    s_xor_b32 s73, s3, 3
    s_lshl_b32 s74, s73, 11
    s_add_u32 s74, s74, s75
    v_add_u32 v26, s74, v1
    v_add_u32 v27, 49152, v26
    s_lshl_b32 s74, s73, 10
    s_add_u32 s74, s74, 65536
    v_add_u32 v38, s74, v3
    v_add_u32 v39, 49152, v38
    v_lshrrev_b32 v1, 2, v0
    s_and_b32 s73, s3, 1
    s_lshl_b32 s73, s73, 5
    v_add_u32 v1, s73, v1
    v_and_b32 v2, 3, v0
    v_lshlrev_b32 v2, 4, v2
    s_lshl_b32 s73, s61, 6
    v_mul_u32_u24 v28, 3072, v1
    v_add3_u32 v28, v28, v2, s73
    v_add_u32 v29, 48128, v28
    buffer_load_dwordx4 v11, s[36:39], s70 offen offset:1024  lds
    s_lshl_b32 s73, s65, 6
    v_mul_u32_u24 v30, 2752, v1
    v_add3_u32 v30, v30, v2, s73
    v_add_u32 v30, s16, v30
    v_add_u32 v31, 43008, v30
    v_and_b32 v1, 15, v0
    v_bfe_u32 v2, v0, 4, 1
    v_sub_u32 v1, v1, v2
    v_mov_b32 v2, 0x3f803f80
    v_cmp_eq_u32 vcc, 0, v1
    s_nop 1
    v_cndmask_b32 v3, 0, v2, vcc
    v_accvgpr_write_b32 a128, v3
    v_accvgpr_write_b32 a129, v3
    v_accvgpr_write_b32 a130, v3
    v_accvgpr_write_b32 a131, v3
    v_cmp_eq_u32 vcc, 2, v1
    s_nop 1
    v_cndmask_b32 v3, 0, v2, vcc
    v_accvgpr_write_b32 a132, v3
    v_accvgpr_write_b32 a133, v3
    v_accvgpr_write_b32 a134, v3
    v_accvgpr_write_b32 a135, v3
    v_cmp_eq_u32 vcc, 4, v1
    s_nop 1
    v_cndmask_b32 v3, 0, v2, vcc
    v_accvgpr_write_b32 a136, v3
    v_accvgpr_write_b32 a137, v3
    v_accvgpr_write_b32 a138, v3
    v_accvgpr_write_b32 a139, v3
    s_lshl_b32 s73, s60, 2
    s_bfe_u32 s85, s83, 196612
    s_add_u32 m0, s71, 16384
    s_lshl_b32 s68, s85, 7
    buffer_load_dwordx4 v4, s[24:27], s68 offen  lds
    s_sub_i32 s73, 8, s73
    v_and_b32 v1, 7, v0
    v_lshlrev_b32 v1, 1, v1
    v_mov_b32 v2, 0x3f80
    v_cmp_le_i32 vcc, s73, v1
    s_nop 1
    v_cndmask_b32 v3, 0, v2, vcc
    v_accvgpr_write_b32 a200, v3
    v_accvgpr_write_b32 a201, 0
    v_add_u32 v1, 1, v1
    v_cmp_le_i32 vcc, s73, v1
    s_nop 1
    v_cndmask_b32 v3, 0, v2, vcc
    v_cmp_ne_u32 vcc, 15, v1
    s_nop 1
    v_cndmask_b32 v3, 0, v3, vcc
    v_accvgpr_write_b32 a202, v3
    v_accvgpr_write_b32 a203, 0
    v_lshlrev_b32 v1, 3, v0
    s_and_b32 s75, s3, 1
    s_lshr_b32 s73, s67, 1
    s_lshl_b32 s74, s73, 13
    s_add_u32 s74, s74, 12845056
    s_lshl_b32 s76, s75, 8
    v_xor_b32 v2, s76, v1
    v_add_u32 v61, s74, v2
    s_lshl_b32 s0, s61, 9
    s_and_b32 s1, s61, 12
    s_lshl_b32 s1, s1, 9
    s_lshl_b32 s73, s73, 8
    s_and_b32 s74, s61, 12
    s_lshl_b32 s74, s74, 3
    buffer_load_dwordx4 v5, s[24:27], s68 offen offset:1024  lds
    s_add_u32 s73, s73, s74
    s_add_u32 s73, s73, 12615680
    v_bfe_u32 v2, v0, 2, 1
    v_and_b32 v3, 3, v0
    v_lshlrev_b32 v3, 3, v3
    v_lshl_add_u32 v2, v2, 7, v3
    v_add_u32 v228, s73, v2
    s_and_b32 s75, s3, 1
    s_mul_i32 s73, s75, 4160
    v_add_u32 v60, s73, v1
    s_lshr_b32 s74, s3, 1
    s_lshl_b32 s76, s74, 8
    s_add_u32 s73, s73, s76
    v_bfe_u32 v1, v0, 1, 3
    v_and_b32 v2, 1, v0
    v_lshrrev_b32 v3, 4, v0
    v_lshl_add_u32 v2, v2, 2, v3
    v_mul_u32_u24 v3, 520, v1
    v_lshl_add_u32 v3, v2, 5, v3
    v_add_u32 v56, s73, v3
    s_lshl_b32 s73, s74, 9
    s_lshl_b32 s76, s75, 3
    s_add_u32 s73, s73, s76
    v_mul_u32_u24 v3, 1040, v1
    v_lshl_add_u32 v3, v2, 6, v3
    v_add_u32 v57, s73, v3
    buffer_load_dwordx4 v6, s[24:27], s68 offen offset:2048  lds
    v_and_b32 v1, 31, v0
    v_lshrrev_b32 v2, 5, v0
    v_lshl_add_u32 v1, v1, 1, v2
    v_lshlrev_b32 v1, 4, v1
    v_add_u32 v1, 2048, v1
    s_and_b32 s73, s61, 1
    s_cmp_eq_u32 s73, 1
    s_cselect_b64 vcc, -1, 0
    v_cndmask_b32 v53, v52, v1, vcc
    s_and_b32 s73, s61, 14
    s_add_u32 s73, s73, s75
    s_lshl_b32 s73, s73, 18
    s_and_b32 s74, s67, -2
    s_lshl_b32 s76, s74, 12
    s_add_u32 s73, s73, s76
    v_add_u32 v53, s73, v53
    s_lshl_b32 s77, s75, 12
    s_mul_i32 s73, s74, 90112
    s_add_u32 s73, s73, 4194304
    s_lshl_b32 s76, s61, 12
    s_add_u32 s73, s73, s76
    s_lshl_b32 s76, s75, 11
    s_add_u32 s73, s73, s76
    v_add_u32 v54, s73, v52
    s_mul_i32 s78, s75, 90112
    s_lshr_b32 s73, s61, 3
    s_lshl_b32 s73, s73, 1
    s_sub_u32 s73, s61, s73
    buffer_load_dwordx4 v7, s[24:27], s68 offen offset:3072  lds
    s_lshl_b32 s73, s73, 11
    s_add_u32 s73, s73, 65536
    s_add_u32 s73, s73, s78
    s_lshl_b32 s76, s61, 12
    s_sub_u32 s73, s73, s76
    s_lshl_b32 s76, s75, 11
    s_sub_u32 s73, s73, s76
    s_and_b32 s66, s61, 7
    s_cmp_lt_u32 s66, 6
    s_cselect_b32 s66, s73, s86
    s_lshl_b32 s73, s74, 7
    s_lshl_b32 s76, s61, 3
    s_add_u32 s76, s76, 12582912
    s_add_u32 s73, s73, s76
    s_lshl_b32 s74, s75, 2
    s_add_u32 s73, s73, s74
    v_lshlrev_b32 v1, 7, v0
    v_add_u32 v1, s73, v1
    v_mov_b32 v2, s86
    v_cmp_gt_u32 vcc, 2, v0
    s_nop 1
    v_cndmask_b32 v55, v2, v1, vcc
    s_lshl_b32 s73, s67, 7
    s_add_u32 s73, s73, s76
    v_mov_b32 v1, s73
    v_cmp_eq_u32 vcc, 0, v0
    s_nop 1
    v_cndmask_b32 v1, v2, v1, vcc
    v_mov_b32 v225, v1
    s_add_u32 m0, s72, 24576
    s_mul_i32 s69, s85, 196608
    buffer_load_dwordx4 v8, s[28:31], s69 offen  lds
    v_mov_b32 v40, 0
    v_mov_b32 v41, 0
    v_mov_b32 v42, 0
    v_mov_b32 v43, 0
    v_mov_b32 v242, 0
    v_mov_b32 v243, 0
    v_mov_b32 v246, 0
    v_mov_b32 v247, 0
    v_mov_b32 v250, 0
    v_mov_b32 v251, 0
    v_and_b32 v193, 31, v0
    v_lshrrev_b32 v194, 5, v0
    v_lshlrev_b32 v194, 2, v194
    v_sub_u32 v193, v193, v194
    v_subrev_u32 v192, 0, v193
    v_ashrrev_i32 v192, 31, v192
    v_and_b32 v192, 0xff000000, v192
    v_accvgpr_write_b32 a232, v192
    v_xor_b32 v192, 0xff000000, v192
    v_accvgpr_write_b32 a216, v192
    v_subrev_u32 v192, 1, v193
    v_ashrrev_i32 v192, 31, v192
    v_and_b32 v192, 0xff000000, v192
    v_accvgpr_write_b32 a233, v192
    v_xor_b32 v192, 0xff000000, v192
    v_accvgpr_write_b32 a217, v192
    v_subrev_u32 v192, 2, v193
    v_ashrrev_i32 v192, 31, v192
    buffer_load_dwordx4 v9, s[28:31], s69 offen offset:1024  lds
    s_add_u32 m0, s72, 32768
    v_and_b32 v192, 0xff000000, v192
    v_accvgpr_write_b32 a234, v192
    v_xor_b32 v192, 0xff000000, v192
    v_accvgpr_write_b32 a218, v192
    v_subrev_u32 v192, 3, v193
    v_ashrrev_i32 v192, 31, v192
    v_and_b32 v192, 0xff000000, v192
    v_accvgpr_write_b32 a235, v192
    v_xor_b32 v192, 0xff000000, v192
    v_accvgpr_write_b32 a219, v192
    v_subrev_u32 v192, 8, v193
    v_ashrrev_i32 v192, 31, v192
    v_and_b32 v192, 0xff000000, v192
    v_accvgpr_write_b32 a236, v192
    v_xor_b32 v192, 0xff000000, v192
    v_accvgpr_write_b32 a220, v192
    v_subrev_u32 v192, 9, v193
    v_ashrrev_i32 v192, 31, v192
    v_and_b32 v192, 0xff000000, v192
    v_accvgpr_write_b32 a237, v192
    v_xor_b32 v192, 0xff000000, v192
    v_accvgpr_write_b32 a221, v192
    v_subrev_u32 v192, 10, v193
    v_ashrrev_i32 v192, 31, v192
    v_and_b32 v192, 0xff000000, v192
    v_accvgpr_write_b32 a238, v192
    v_xor_b32 v192, 0xff000000, v192
    s_mul_i32 s70, s85, 176128
    buffer_load_dwordx4 v10, s[32:35], s70 offen  lds
    v_accvgpr_write_b32 a222, v192
    v_subrev_u32 v192, 11, v193
    v_ashrrev_i32 v192, 31, v192
    v_and_b32 v192, 0xff000000, v192
    v_accvgpr_write_b32 a239, v192
    v_xor_b32 v192, 0xff000000, v192
    v_accvgpr_write_b32 a223, v192
    v_subrev_u32 v192, 16, v193
    v_ashrrev_i32 v192, 31, v192
    v_and_b32 v192, 0xff000000, v192
    v_accvgpr_write_b32 a240, v192
    v_xor_b32 v192, 0xff000000, v192
    v_accvgpr_write_b32 a224, v192
    v_subrev_u32 v192, 17, v193
    v_ashrrev_i32 v192, 31, v192
    v_and_b32 v192, 0xff000000, v192
    v_accvgpr_write_b32 a241, v192
    v_xor_b32 v192, 0xff000000, v192
    v_accvgpr_write_b32 a225, v192
    v_subrev_u32 v192, 18, v193
    v_ashrrev_i32 v192, 31, v192
    v_and_b32 v192, 0xff000000, v192
    v_accvgpr_write_b32 a242, v192
    v_xor_b32 v192, 0xff000000, v192
    v_accvgpr_write_b32 a226, v192
    v_subrev_u32 v192, 19, v193
    v_ashrrev_i32 v192, 31, v192
    v_and_b32 v192, 0xff000000, v192
    buffer_load_dwordx4 v11, s[32:35], s70 offen offset:1024  lds
    s_add_u32 m0, s72, 40960
    v_accvgpr_write_b32 a243, v192
    v_xor_b32 v192, 0xff000000, v192
    v_accvgpr_write_b32 a227, v192
    v_subrev_u32 v192, 24, v193
    v_ashrrev_i32 v192, 31, v192
    v_and_b32 v192, 0xff000000, v192
    v_accvgpr_write_b32 a244, v192
    v_xor_b32 v192, 0xff000000, v192
    v_accvgpr_write_b32 a228, v192
    v_subrev_u32 v192, 25, v193
    v_ashrrev_i32 v192, 31, v192
    v_and_b32 v192, 0xff000000, v192
    v_accvgpr_write_b32 a245, v192
    v_xor_b32 v192, 0xff000000, v192
    v_accvgpr_write_b32 a229, v192
    v_subrev_u32 v192, 26, v193
    v_ashrrev_i32 v192, 31, v192
    v_and_b32 v192, 0xff000000, v192
    v_accvgpr_write_b32 a246, v192
    v_xor_b32 v192, 0xff000000, v192
    v_accvgpr_write_b32 a230, v192
    v_subrev_u32 v192, 27, v193
    v_ashrrev_i32 v192, 31, v192
    v_and_b32 v192, 0xff000000, v192
    v_accvgpr_write_b32 a247, v192
    v_xor_b32 v192, 0xff000000, v192
    v_accvgpr_write_b32 a231, v192
    s_cmp_lg_u32 s2, 0
    s_cselect_b32 s73, s86, 0
    s_lshl_b32 s74, s3, 2
    s_add_u32 s73, s73, s74
    v_mov_b32 v1, 1
    v_lshlrev_b32 v2, 8, v0
    s_waitcnt vmcnt(8)
    buffer_store_dword v1, v2, s[56:59], s73 offen sc1
    s_barrier
    ds_read_b128 a[0:3], v12 offset:0
    ds_read_b64_tr_b16 a[152:153], v20 offset:0
    ds_read_b64_tr_b16 a[154:155], v20 offset:512
    ds_read_b128 a[140:143], v16 offset:0
    ds_read_b64_tr_b16 a[156:157], v20 offset:8192
    ds_read_b64_tr_b16 a[158:159], v20 offset:8704
    ds_read_b64_tr_b16 a[160:161], v20 offset:16384
    ds_read_b64_tr_b16 a[162:163], v20 offset:16896
    ds_read_b128 v[160:163], v12 offset:0
    ds_read_b128 v[164:167], v13 offset:0
    s_waitcnt lgkmcnt(1)
    v_lshlrev_b32 v232, 16, v160
    v_and_b32 v233, 0xffff0000, v160
    v_add_f32 v40, v40, v232
    v_add_f32 v41, v41, v233
    v_fmac_f32 v42, v232, v232
    v_fmac_f32 v43, v233, v233
    v_lshlrev_b32 v234, 16, v161
    v_and_b32 v235, 0xffff0000, v161
    v_add_f32 v40, v40, v234
    v_add_f32 v41, v41, v235
    v_fmac_f32 v42, v234, v234
    v_fmac_f32 v43, v235, v235
    v_lshlrev_b32 v232, 16, v162
    v_and_b32 v233, 0xffff0000, v162
    v_add_f32 v40, v40, v232
    v_add_f32 v41, v41, v233
    v_fmac_f32 v42, v232, v232
    v_fmac_f32 v43, v233, v233
    v_lshlrev_b32 v234, 16, v163
    v_and_b32 v235, 0xffff0000, v163
    v_add_f32 v40, v40, v234
    v_add_f32 v41, v41, v235
    v_fmac_f32 v42, v234, v234
    v_fmac_f32 v43, v235, v235
    s_waitcnt lgkmcnt(0)
    v_mfma_f32_32x32x16_bf16 v[64:79], a[152:155], a[0:3], 0
    ds_read_b128 a[4:7], v13 offset:0
    ds_read_b64_tr_b16 a[164:165], v22 offset:0
    buffer_load_dwordx4 v10, s[36:39], s70 offen  lds
    v_lshlrev_b32 v232, 16, v164
    v_and_b32 v233, 0xffff0000, v164
    v_add_f32 v40, v40, v232
    v_mfma_f32_32x32x16_bf16 v[80:95], a[152:155], a[140:143], 0
    ds_read_b64_tr_b16 a[166:167], v22 offset:512
    ds_read_b128 a[144:147], v17 offset:0
    ds_read_b64_tr_b16 a[168:169], v22 offset:8192
    buffer_load_dwordx4 v11, s[36:39], s70 offen offset:1024  lds
    v_add_f32 v41, v41, v233
    v_fmac_f32 v42, v232, v232
    v_fmac_f32 v43, v233, v233
    v_mfma_f32_16x16x32_bf16 v[44:47], a[152:155], a[128:131], 0
    v_lshlrev_b32 v234, 16, v165
    v_and_b32 v235, 0xffff0000, v165
    v_mfma_f32_32x32x16_bf16 v[96:111], a[156:159], a[0:3], 0
    ds_read_b64_tr_b16 a[170:171], v22 offset:8704
    v_add_f32 v40, v40, v234
    v_add_f32 v41, v41, v235
    v_fmac_f32 v42, v234, v234
    v_mfma_f32_32x32x16_bf16 v[112:127], a[156:159], a[140:143], 0
    ds_read_b64_tr_b16 a[172:173], v22 offset:16384
    ds_read_b64_tr_b16 a[174:175], v22 offset:16896
    ds_read_b128 v[168:171], v14 offset:0
    s_bfe_u32 s85, s83, 196616
    s_add_u32 m0, s71, 32768
    s_lshl_b32 s68, s85, 7
    buffer_load_dwordx4 v4, s[24:27], s68 offen  lds
    v_fmac_f32 v43, v235, v235
    v_lshlrev_b32 v232, 16, v166
    v_and_b32 v233, 0xffff0000, v166
    v_mfma_f32_16x16x32_bf16 v[44:47], a[156:159], a[132:135], v[44:47]
    v_add_f32 v40, v40, v232
    v_add_f32 v41, v41, v233
    v_mfma_f32_32x32x16_bf16 v[128:143], a[160:163], a[0:3], 0
    buffer_load_dwordx4 v5, s[24:27], s68 offen offset:1024  lds
    v_fmac_f32 v42, v232, v232
    v_fmac_f32 v43, v233, v233
    v_lshlrev_b32 v234, 16, v167
    v_mfma_f32_32x32x16_bf16 v[144:159], a[160:163], a[140:143], 0
    buffer_load_dwordx4 v6, s[24:27], s68 offen offset:2048  lds
    v_and_b32 v235, 0xffff0000, v167
    v_add_f32 v40, v40, v234
    v_add_f32 v41, v41, v235
    v_mfma_f32_16x16x32_bf16 v[44:47], a[160:163], a[136:139], v[44:47]
    v_fmac_f32 v42, v234, v234
    v_fmac_f32 v43, v235, v235
    s_waitcnt lgkmcnt(0)
    v_mfma_f32_32x32x16_bf16 v[64:79], a[164:167], a[4:7], v[64:79]
    ds_read_b128 a[8:11], v14 offset:0
    ds_read_b64_tr_b16 a[152:153], v24 offset:0
    v_lshlrev_b32 v232, 16, v168
    v_and_b32 v233, 0xffff0000, v168
    v_add_f32 v40, v40, v232
    v_mfma_f32_32x32x16_bf16 v[80:95], a[164:167], a[144:147], v[80:95]
    ds_read_b64_tr_b16 a[154:155], v24 offset:512
    ds_read_b128 a[140:143], v18 offset:0
    ds_read_b64_tr_b16 a[156:157], v24 offset:8192
    buffer_load_dwordx4 v7, s[24:27], s68 offen offset:3072  lds
    v_add_f32 v41, v41, v233
    v_fmac_f32 v42, v232, v232
    v_fmac_f32 v43, v233, v233
    v_mfma_f32_16x16x32_bf16 v[44:47], a[164:167], a[128:131], v[44:47]
    v_lshlrev_b32 v234, 16, v169
    v_and_b32 v235, 0xffff0000, v169
    v_mfma_f32_32x32x16_bf16 v[96:111], a[168:171], a[4:7], v[96:111]
    ds_read_b64_tr_b16 a[158:159], v24 offset:8704
    s_add_u32 m0, s72, 49152
    s_mul_i32 s69, s85, 196608
    buffer_load_dwordx4 v8, s[28:31], s69 offen  lds
    v_add_f32 v40, v40, v234
    v_add_f32 v41, v41, v235
    v_fmac_f32 v42, v234, v234
    v_mfma_f32_32x32x16_bf16 v[112:127], a[168:171], a[144:147], v[112:127]
    ds_read_b64_tr_b16 a[160:161], v24 offset:16384
    ds_read_b64_tr_b16 a[162:163], v24 offset:16896
    ds_read_b128 v[172:175], v15 offset:0
    buffer_load_dwordx4 v9, s[28:31], s69 offen offset:1024  lds
    s_add_u32 m0, s72, 57344
    v_fmac_f32 v43, v235, v235
    v_lshlrev_b32 v232, 16, v170
    v_and_b32 v233, 0xffff0000, v170
    v_mfma_f32_16x16x32_bf16 v[44:47], a[168:171], a[132:135], v[44:47]
    v_add_f32 v40, v40, v232
    v_add_f32 v41, v41, v233
    v_mfma_f32_32x32x16_bf16 v[128:143], a[172:175], a[4:7], v[128:143]
    v_fmac_f32 v42, v232, v232
    v_fmac_f32 v43, v233, v233
    v_lshlrev_b32 v234, 16, v171
    v_mfma_f32_32x32x16_bf16 v[144:159], a[172:175], a[144:147], v[144:159]
    s_mul_i32 s70, s85, 176128
    buffer_load_dwordx4 v10, s[32:35], s70 offen  lds
    v_and_b32 v235, 0xffff0000, v171
    v_add_f32 v40, v40, v234
    v_add_f32 v41, v41, v235
    v_mfma_f32_16x16x32_bf16 v[44:47], a[172:175], a[136:139], v[44:47]
    v_fmac_f32 v42, v234, v234
    v_fmac_f32 v43, v235, v235
    s_waitcnt lgkmcnt(0)
    v_mfma_f32_32x32x16_bf16 v[64:79], a[152:155], a[8:11], v[64:79]
    ds_read_b128 a[12:15], v15 offset:0
    ds_read_b64_tr_b16 a[164:165], v26 offset:0
    buffer_load_dwordx4 v11, s[32:35], s70 offen offset:1024  lds
    s_add_u32 m0, s72, 65536
    v_lshlrev_b32 v232, 16, v172
    v_and_b32 v233, 0xffff0000, v172
    v_add_f32 v40, v40, v232
    v_add_f32 v41, v41, v233
    v_mfma_f32_32x32x16_bf16 v[80:95], a[152:155], a[140:143], v[80:95]
    ds_read_b64_tr_b16 a[166:167], v26 offset:512
    ds_read_b128 a[144:147], v19 offset:0
    v_fmac_f32 v42, v232, v232
    v_fmac_f32 v43, v233, v233
    v_lshlrev_b32 v234, 16, v173
    v_and_b32 v235, 0xffff0000, v173
    v_mfma_f32_32x32x16_bf16 v[96:111], a[156:159], a[8:11], v[96:111]
    ds_read_b64_tr_b16 a[168:169], v26 offset:8192
    ds_read_b64_tr_b16 a[170:171], v26 offset:8704
    buffer_load_dwordx4 v10, s[36:39], s70 offen  lds
    v_add_f32 v40, v40, v234
    v_add_f32 v41, v41, v235
    v_fmac_f32 v42, v234, v234
    v_fmac_f32 v43, v235, v235
    v_mfma_f32_32x32x16_bf16 v[112:127], a[156:159], a[140:143], v[112:127]
    ds_read_b64_tr_b16 a[172:173], v26 offset:16384
    ds_read_b64_tr_b16 a[174:175], v26 offset:16896
    buffer_load_dwordx4 v11, s[36:39], s70 offen offset:1024  lds
    v_lshlrev_b32 v232, 16, v174
    v_and_b32 v233, 0xffff0000, v174
    v_add_f32 v40, v40, v232
    v_add_f32 v41, v41, v233
    v_mfma_f32_32x32x16_bf16 v[128:143], a[160:163], a[8:11], v[128:143]
    v_fmac_f32 v42, v232, v232
    v_fmac_f32 v43, v233, v233
    v_lshlrev_b32 v234, 16, v175
    v_and_b32 v235, 0xffff0000, v175
    v_mfma_f32_32x32x16_bf16 v[144:159], a[160:163], a[140:143], v[144:159]
    s_mul_i32 s73, s2, 3
    s_add_u32 s73, s73, s3
    s_mov_b32 s7, 0x20000
    s_cmp_eq_u32 s3, 3
    s_cselect_b32 s73, s2, s73
    s_cselect_b32 s4, s44, s40
    s_cselect_b32 s5, s45, s41
    s_cselect_b32 s6, s46, s42
    s_lshl_b32 s73, s73, 11
    v_and_b32 v1, 15, v0
    v_lshlrev_b32 v1, 7, v1
    v_lshrrev_b32 v2, 4, v0
    v_lshl_add_u32 v1, v2, 28, v1
    buffer_load_dword v58, v1, s[4:7], s73 offen sc1
    v_add_f32 v40, v40, v234
    v_add_f32 v41, v41, v235
    v_fmac_f32 v42, v234, v234
    v_fmac_f32 v43, v235, v235
    s_waitcnt lgkmcnt(0)
    s_waitcnt vmcnt(11)
    s_barrier
    v_mfma_f32_32x32x16_bf16 v[64:79], a[164:167], a[12:15], v[64:79]
    ds_read_b128 v[160:163], v12 offset:16384
    ds_read_b128 a[16:19], v12 offset:16384
    ds_read_b64_tr_b16 a[152:153], v20 offset:24576
    v_mfma_f32_32x32x16_bf16 v[80:95], a[164:167], a[144:147], v[80:95]
    ds_read_b64_tr_b16 a[154:155], v20 offset:25088
    ds_read_b128 a[140:143], v16 offset:16384
    s_bfe_u32 s85, s83, 196620
    s_add_u32 m0, s71, 49152
    s_lshl_b32 s68, s85, 7
    buffer_load_dwordx4 v4, s[24:27], s68 offen  lds
    v_mfma_f32_32x32x16_bf16 v[96:111], a[168:171], a[12:15], v[96:111]
    ds_read_b64_tr_b16 a[156:157], v20 offset:32768
    ds_read_b64_tr_b16 a[158:159], v20 offset:33280
    ds_read_b64_tr_b16 a[160:161], v20 offset:40960
    s_waitcnt lgkmcnt(7)
    v_lshlrev_b32 v232, 16, v160
    v_and_b32 v233, 0xffff0000, v160
    v_add_f32 v40, v40, v232
    v_add_f32 v41, v41, v233
    v_fmac_f32 v42, v232, v232
    v_fmac_f32 v43, v233, v233
    v_mfma_f32_32x32x16_bf16 v[112:127], a[168:171], a[144:147], v[112:127]
    ds_read_b64_tr_b16 a[162:163], v20 offset:41472
    ds_read_b128 v[164:167], v13 offset:16384
    buffer_load_dwordx4 v5, s[24:27], s68 offen offset:1024  lds
    v_lshlrev_b32 v234, 16, v161
    v_and_b32 v235, 0xffff0000, v161
    v_add_f32 v40, v40, v234
    v_add_f32 v41, v41, v235
    v_fmac_f32 v42, v234, v234
    v_fmac_f32 v43, v235, v235
    v_mfma_f32_32x32x16_bf16 v[128:143], a[172:175], a[12:15], v[128:143]
    v_lshlrev_b32 v232, 16, v162
    v_and_b32 v233, 0xffff0000, v162
    v_add_f32 v40, v40, v232
    v_add_f32 v41, v41, v233
    v_fmac_f32 v42, v232, v232
    v_fmac_f32 v43, v233, v233
    v_mfma_f32_32x32x16_bf16 v[144:159], a[172:175], a[144:147], v[144:159]
    v_lshlrev_b32 v234, 16, v163
    v_and_b32 v235, 0xffff0000, v163
    v_add_f32 v40, v40, v234
    v_add_f32 v41, v41, v235
    v_fmac_f32 v42, v234, v234
    v_fmac_f32 v43, v235, v235
    s_waitcnt lgkmcnt(0)
    v_mfma_f32_32x32x16_bf16 v[64:79], a[152:155], a[16:19], v[64:79]
    ds_read_b128 a[20:23], v13 offset:16384
    ds_read_b64_tr_b16 a[164:165], v22 offset:24576
    buffer_load_dwordx4 v6, s[24:27], s68 offen offset:2048  lds
    v_and_b32 v3, 3, v0
    v_lshlrev_b32 v3, 2, v3
    buffer_load_dword v59, v3, s[56:59], 0 offen sc1
    v_lshlrev_b32 v232, 16, v164
    v_and_b32 v233, 0xffff0000, v164
    v_add_f32 v40, v40, v232
    v_mfma_f32_32x32x16_bf16 v[80:95], a[152:155], a[140:143], v[80:95]
    ds_read_b64_tr_b16 a[166:167], v22 offset:25088
    ds_read_b128 a[144:147], v17 offset:16384
    ds_read_b64_tr_b16 a[168:169], v22 offset:32768
    v_add_f32 v41, v41, v233
    v_fmac_f32 v42, v232, v232
    v_fmac_f32 v43, v233, v233
    v_mfma_f32_16x16x32_bf16 v[44:47], a[152:155], a[128:131], v[44:47]
    v_lshlrev_b32 v234, 16, v165
    v_and_b32 v235, 0xffff0000, v165
    v_mfma_f32_32x32x16_bf16 v[96:111], a[156:159], a[16:19], v[96:111]
    ds_read_b64_tr_b16 a[170:171], v22 offset:33280
    buffer_load_dwordx4 v7, s[24:27], s68 offen offset:3072  lds
    v_add_f32 v40, v40, v234
    v_add_f32 v41, v41, v235
    v_fmac_f32 v42, v234, v234
    v_mfma_f32_32x32x16_bf16 v[112:127], a[156:159], a[140:143], v[112:127]
    ds_read_b64_tr_b16 a[172:173], v22 offset:40960
    ds_read_b64_tr_b16 a[174:175], v22 offset:41472
    ds_read_b128 v[168:171], v14 offset:16384
    v_fmac_f32 v43, v235, v235
    v_lshlrev_b32 v232, 16, v166
    v_and_b32 v233, 0xffff0000, v166
    v_mfma_f32_16x16x32_bf16 v[44:47], a[156:159], a[132:135], v[44:47]
    v_add_f32 v40, v40, v232
    v_add_f32 v41, v41, v233
    v_mfma_f32_32x32x16_bf16 v[128:143], a[160:163], a[16:19], v[128:143]
    v_fmac_f32 v42, v232, v232
    v_fmac_f32 v43, v233, v233
    v_lshlrev_b32 v234, 16, v167
    v_mfma_f32_32x32x16_bf16 v[144:159], a[160:163], a[140:143], v[144:159]
    s_add_u32 m0, s72, 73728
    s_mul_i32 s69, s85, 196608
    buffer_load_dwordx4 v8, s[28:31], s69 offen  lds
    v_and_b32 v235, 0xffff0000, v167
    v_add_f32 v40, v40, v234
    v_add_f32 v41, v41, v235
    v_mfma_f32_16x16x32_bf16 v[44:47], a[160:163], a[136:139], v[44:47]
    v_fmac_f32 v42, v234, v234
    v_fmac_f32 v43, v235, v235
    s_waitcnt lgkmcnt(0)
    v_mfma_f32_32x32x16_bf16 v[64:79], a[164:167], a[20:23], v[64:79]
    ds_read_b128 a[24:27], v14 offset:16384
    ds_read_b64_tr_b16 a[152:153], v24 offset:24576
    v_lshlrev_b32 v232, 16, v168
    v_and_b32 v233, 0xffff0000, v168
    v_add_f32 v40, v40, v232
    v_mfma_f32_32x32x16_bf16 v[80:95], a[164:167], a[144:147], v[80:95]
    ds_read_b64_tr_b16 a[154:155], v24 offset:25088
    ds_read_b128 a[140:143], v18 offset:16384
    ds_read_b64_tr_b16 a[156:157], v24 offset:32768
    buffer_load_dwordx4 v9, s[28:31], s69 offen offset:1024  lds
    s_add_u32 m0, s72, 81920
    v_add_f32 v41, v41, v233
    v_fmac_f32 v42, v232, v232
    v_fmac_f32 v43, v233, v233
    v_mfma_f32_16x16x32_bf16 v[44:47], a[164:167], a[128:131], v[44:47]
    v_lshlrev_b32 v234, 16, v169
    v_and_b32 v235, 0xffff0000, v169
    v_mfma_f32_32x32x16_bf16 v[96:111], a[168:171], a[20:23], v[96:111]
    ds_read_b64_tr_b16 a[158:159], v24 offset:33280
    v_add_f32 v40, v40, v234
    v_add_f32 v41, v41, v235
    v_fmac_f32 v42, v234, v234
    v_mfma_f32_32x32x16_bf16 v[112:127], a[168:171], a[144:147], v[112:127]
    ds_read_b64_tr_b16 a[160:161], v24 offset:40960
    ds_read_b64_tr_b16 a[162:163], v24 offset:41472
    ds_read_b128 v[172:175], v15 offset:16384
    s_mul_i32 s70, s85, 176128
    buffer_load_dwordx4 v10, s[32:35], s70 offen  lds
    v_fmac_f32 v43, v235, v235
    v_lshlrev_b32 v232, 16, v170
    v_and_b32 v233, 0xffff0000, v170
    v_mfma_f32_16x16x32_bf16 v[44:47], a[168:171], a[132:135], v[44:47]
    v_add_f32 v40, v40, v232
    v_add_f32 v41, v41, v233
    v_mfma_f32_32x32x16_bf16 v[128:143], a[172:175], a[20:23], v[128:143]
    v_fmac_f32 v42, v232, v232
    v_fmac_f32 v43, v233, v233
    v_lshlrev_b32 v234, 16, v171
    v_mfma_f32_32x32x16_bf16 v[144:159], a[172:175], a[144:147], v[144:159]
    buffer_load_dwordx4 v11, s[32:35], s70 offen offset:1024  lds
    s_add_u32 m0, s72, 90112
    v_and_b32 v235, 0xffff0000, v171
    v_add_f32 v40, v40, v234
    v_add_f32 v41, v41, v235
    v_mfma_f32_16x16x32_bf16 v[44:47], a[172:175], a[136:139], v[44:47]
    v_fmac_f32 v42, v234, v234
    v_fmac_f32 v43, v235, v235
    s_waitcnt lgkmcnt(0)
    v_mfma_f32_32x32x16_bf16 v[64:79], a[152:155], a[24:27], v[64:79]
    ds_read_b128 a[28:31], v15 offset:16384
    ds_read_b64_tr_b16 a[164:165], v26 offset:24576
    v_lshlrev_b32 v232, 16, v172
    v_and_b32 v233, 0xffff0000, v172
    v_add_f32 v40, v40, v232
    v_add_f32 v41, v41, v233
    v_mfma_f32_32x32x16_bf16 v[80:95], a[152:155], a[140:143], v[80:95]
    ds_read_b64_tr_b16 a[166:167], v26 offset:25088
    ds_read_b128 a[144:147], v19 offset:16384
    v_fmac_f32 v42, v232, v232
    v_fmac_f32 v43, v233, v233
    v_lshlrev_b32 v234, 16, v173
    v_and_b32 v235, 0xffff0000, v173
    v_mfma_f32_32x32x16_bf16 v[96:111], a[156:159], a[24:27], v[96:111]
    ds_read_b64_tr_b16 a[168:169], v26 offset:32768
    ds_read_b64_tr_b16 a[170:171], v26 offset:33280
    buffer_load_dwordx4 v10, s[36:39], s70 offen  lds
    v_add_f32 v40, v40, v234
    v_add_f32 v41, v41, v235
    v_fmac_f32 v42, v234, v234
    v_fmac_f32 v43, v235, v235
    v_mfma_f32_32x32x16_bf16 v[112:127], a[156:159], a[140:143], v[112:127]
    ds_read_b64_tr_b16 a[172:173], v26 offset:40960
    ds_read_b64_tr_b16 a[174:175], v26 offset:41472
    v_lshlrev_b32 v232, 16, v174
    v_and_b32 v233, 0xffff0000, v174
    v_add_f32 v40, v40, v232
    v_add_f32 v41, v41, v233
    v_mfma_f32_32x32x16_bf16 v[128:143], a[160:163], a[24:27], v[128:143]
    buffer_load_dwordx4 v11, s[36:39], s70 offen offset:1024  lds
    v_fmac_f32 v42, v232, v232
    v_fmac_f32 v43, v233, v233
    v_lshlrev_b32 v234, 16, v175
    v_and_b32 v235, 0xffff0000, v175
    v_mfma_f32_32x32x16_bf16 v[144:159], a[160:163], a[140:143], v[144:159]
    v_add_f32 v40, v40, v234
    v_add_f32 v41, v41, v235
    v_fmac_f32 v42, v234, v234
    v_fmac_f32 v43, v235, v235
    s_waitcnt lgkmcnt(0)
    s_waitcnt vmcnt(12)
    s_barrier
    v_mfma_f32_32x32x16_bf16 v[64:79], a[164:167], a[28:31], v[64:79]
    ds_read_b128 a[32:35], v12 offset:32768
    ds_read_b64_tr_b16 a[152:153], v21 offset:0
    v_add_f32 v40, v40, v41
    v_add_f32 v41, v42, v43
    v_mov_b32 v42, v40
    v_mov_b32 v43, v41
    v_mfma_f32_32x32x16_bf16 v[80:95], a[164:167], a[144:147], v[80:95]
    ds_read_b64_tr_b16 a[154:155], v21 offset:512
    ds_read_b128 a[140:143], v16 offset:32768
    s_bfe_u32 s85, s83, 196624
    s_add_u32 m0, s71, 0
    s_lshl_b32 s68, s85, 7
    buffer_load_dwordx4 v4, s[24:27], s68 offen  lds
    v_lshrrev_b32 v1, 5, v0
    v_permlane32_swap_b32 v40, v42
    v_permlane32_swap_b32 v41, v43
    v_mfma_f32_32x32x16_bf16 v[96:111], a[168:171], a[28:31], v[96:111]
    ds_read_b64_tr_b16 a[156:157], v21 offset:8192
    ds_read_b64_tr_b16 a[158:159], v21 offset:8704
    s_lshl_b32 s4, s63, 7
    v_add_u32 v62, s4, v62
    v_lshl_add_u32 v1, v1, 28, v61
    v_add_f32 v40, v40, v42
    v_add_f32 v41, v41, v43
    v_mfma_f32_32x32x16_bf16 v[112:127], a[168:171], a[144:147], v[112:127]
    ds_read_b64_tr_b16 a[160:161], v21 offset:16384
    ds_read_b64_tr_b16 a[162:163], v21 offset:16896
    buffer_store_dwordx2 v[40:41], v1, s[52:55], s0 offen sc1
    buffer_load_dwordx4 v5, s[24:27], s68 offen offset:1024  lds
    v_add_u32 v63, 7168, v62
    s_lshl_b32 s4, s3, 17
    v_mfma_f32_32x32x16_bf16 v[128:143], a[172:175], a[28:31], v[128:143]
    v_add_u32 v192, s4, v62
    v_mov_b32 v219, v192
    v_mfma_f32_32x32x16_bf16 v[144:159], a[172:175], a[144:147], v[144:159]
    v_add_u32 v192, 7168, v192
    v_mov_b32 v220, v192
    s_waitcnt lgkmcnt(0)
    v_mfma_f32_32x32x16_bf16 v[64:79], a[152:155], a[32:35], v[64:79]
    ds_read_b128 a[36:39], v13 offset:32768
    ds_read_b64_tr_b16 a[164:165], v23 offset:0
    buffer_load_dwordx4 v6, s[24:27], s68 offen offset:2048  lds
    s_mul_i32 s4, s62, 180224
    s_lshl_b32 s5, s3, 14
    s_add_u32 s4, s4, s5
    v_mfma_f32_32x32x16_bf16 v[80:95], a[152:155], a[140:143], v[80:95]
    ds_read_b64_tr_b16 a[166:167], v23 offset:512
    ds_read_b128 a[144:147], v17 offset:32768
    v_mfma_f32_16x16x32_bf16 v[44:47], a[152:155], a[128:131], v[44:47]
    s_add_u32 s4, s4, 4194304
    v_add_u32 v192, s4, v52
    v_mfma_f32_32x32x16_bf16 v[96:111], a[156:159], a[32:35], v[96:111]
    ds_read_b64_tr_b16 a[168:169], v23 offset:8192
    ds_read_b64_tr_b16 a[170:171], v23 offset:8704
    buffer_load_dwordx4 v7, s[24:27], s68 offen offset:3072  lds
    v_mov_b32 v221, v192
    v_add_u32 v192, 90112, v192
    v_mov_b32 v222, v192
    v_mfma_f32_32x32x16_bf16 v[112:127], a[156:159], a[140:143], v[112:127]
    ds_read_b64_tr_b16 a[172:173], v23 offset:16384
    ds_read_b64_tr_b16 a[174:175], v23 offset:16896
    v_mfma_f32_16x16x32_bf16 v[44:47], a[156:159], a[132:135], v[44:47]
    s_lshl_b32 s4, s62, 16
    s_lshl_b32 s5, s3, 13
    v_mfma_f32_32x32x16_bf16 v[128:143], a[160:163], a[32:35], v[128:143]
    s_add_u32 s4, s4, s5
    s_add_u32 s4, s4, 10485760
    v_mfma_f32_32x32x16_bf16 v[144:159], a[160:163], a[140:143], v[144:159]
    s_add_u32 m0, s72, 0
    s_mul_i32 s69, s85, 196608
    buffer_load_dwordx4 v8, s[28:31], s69 offen  lds
    v_add_u32 v192, s4, v52
    v_mfma_f32_16x16x32_bf16 v[44:47], a[160:163], a[136:139], v[44:47]
    v_mov_b32 v223, v192
    v_add_u32 v192, 32768, v192
    s_waitcnt lgkmcnt(0)
    v_mfma_f32_32x32x16_bf16 v[64:79], a[164:167], a[36:39], v[64:79]
    ds_read_b128 a[40:43], v14 offset:32768
    ds_read_b64_tr_b16 a[152:153], v25 offset:0
    v_mov_b32 v224, v192
    s_lshl_b32 s11, s62, 1
    v_mfma_f32_32x32x16_bf16 v[80:95], a[164:167], a[144:147], v[80:95]
    ds_read_b64_tr_b16 a[154:155], v25 offset:512
    ds_read_b128 a[140:143], v18 offset:32768
    buffer_load_dwordx4 v9, s[28:31], s69 offen offset:1024  lds
    s_add_u32 m0, s72, 8192
    s_add_u32 s11, s11, s63
    v_mfma_f32_16x16x32_bf16 v[44:47], a[164:167], a[128:131], v[44:47]
    s_and_b32 s11, s11, 7
    s_lshl_b32 s12, s3, 2
    v_mfma_f32_32x32x16_bf16 v[96:111], a[168:171], a[36:39], v[96:111]
    ds_read_b64_tr_b16 a[156:157], v25 offset:8192
    ds_read_b64_tr_b16 a[158:159], v25 offset:8704
    s_add_u32 s4, s11, 0
    s_bfe_u32 s5, s4, 0x20001
    v_mfma_f32_32x32x16_bf16 v[112:127], a[168:171], a[144:147], v[112:127]
    ds_read_b64_tr_b16 a[160:161], v25 offset:16384
    ds_read_b64_tr_b16 a[162:163], v25 offset:16896
    s_mul_i32 s70, s85, 176128
    buffer_load_dwordx4 v10, s[32:35], s70 offen  lds
    s_add_u32 s5, s5, s12
    v_mfma_f32_16x16x32_bf16 v[44:47], a[168:171], a[132:135], v[44:47]
    s_lshl_b32 s7, s5, 1
    s_lshr_b32 s7, 0x3aaa4000, s7
    v_mfma_f32_32x32x16_bf16 v[128:143], a[172:175], a[36:39], v[128:143]
    s_and_b32 s7, s7, 3
    s_mul_i32 s6, s5, 3
    v_mfma_f32_32x32x16_bf16 v[144:159], a[172:175], a[144:147], v[144:159]
    buffer_load_dwordx4 v11, s[32:35], s70 offen offset:1024  lds
    s_add_u32 m0, s72, 16384
    s_sub_u32 s6, s6, s7
    v_mfma_f32_16x16x32_bf16 v[44:47], a[172:175], a[136:139], v[44:47]
    s_min_u32 s6, s6, 41
    s_and_b32 s4, s4, 1
    s_waitcnt lgkmcnt(0)
    v_mfma_f32_32x32x16_bf16 v[64:79], a[152:155], a[40:43], v[64:79]
    ds_read_b128 a[44:47], v15 offset:32768
    ds_read_b64_tr_b16 a[164:165], v27 offset:0
    s_add_u32 s4, s4, s6
    s_lshl_b32 s94, s4, 15
    v_mfma_f32_32x32x16_bf16 v[80:95], a[152:155], a[140:143], v[80:95]
    ds_read_b64_tr_b16 a[166:167], v27 offset:512
    ds_read_b128 a[144:147], v19 offset:32768
    s_add_u32 s4, s11, 0
    s_and_b32 s4, s4, 7
    v_mfma_f32_32x32x16_bf16 v[96:111], a[156:159], a[40:43], v[96:111]
    ds_read_b64_tr_b16 a[168:169], v27 offset:8192
    ds_read_b64_tr_b16 a[170:171], v27 offset:8704
    buffer_load_dwordx4 v10, s[36:39], s70 offen  lds
    s_lshl_b32 s18, s4, 11
    s_add_u32 s4, s11, 1
    s_bfe_u32 s5, s4, 0x20001
    v_mfma_f32_32x32x16_bf16 v[112:127], a[156:159], a[140:143], v[112:127]
    ds_read_b64_tr_b16 a[172:173], v27 offset:16384
    ds_read_b64_tr_b16 a[174:175], v27 offset:16896
    s_add_u32 s5, s5, s12
    s_lshl_b32 s7, s5, 1
    v_mfma_f32_32x32x16_bf16 v[128:143], a[160:163], a[40:43], v[128:143]
    buffer_load_dwordx4 v11, s[36:39], s70 offen offset:1024  lds
    s_lshr_b32 s7, 0x3aaa4000, s7
    s_and_b32 s7, s7, 3
    v_mfma_f32_32x32x16_bf16 v[144:159], a[160:163], a[140:143], v[144:159]
    s_mul_i32 s6, s5, 3
    s_sub_u32 s6, s6, s7
    s_waitcnt lgkmcnt(0)
    s_waitcnt vmcnt(11)
    s_barrier
    v_mfma_f32_32x32x16_bf16 v[64:79], a[164:167], a[44:47], v[64:79]
    ds_read_b128 a[48:51], v12 offset:49152
    ds_read_b64_tr_b16 a[152:153], v21 offset:24576
    s_min_u32 s6, s6, 41
    s_and_b32 s4, s4, 1
    v_mfma_f32_32x32x16_bf16 v[80:95], a[164:167], a[144:147], v[80:95]
    ds_read_b64_tr_b16 a[154:155], v21 offset:25088
    ds_read_b128 a[140:143], v16 offset:49152
    s_bfe_u32 s85, s83, 196628
    s_add_u32 m0, s71, 16384
    s_lshl_b32 s68, s85, 7
    buffer_load_dwordx4 v4, s[24:27], s68 offen  lds
    s_add_u32 s4, s4, s6
    s_lshl_b32 s95, s4, 15
    v_cmp_eq_u32 vcc, 0, v59
    s_nop 0
    s_cbranch_vccnz L_spin_init
L_ok_init:
    v_mov_b32 v1, 1
    s_mov_b32 s73, 32768
    s_waitcnt vmcnt(10)
    buffer_store_dword v1, v225, s[52:55], s73 offen sc1
    v_mfma_f32_32x32x16_bf16 v[96:111], a[168:171], a[44:47], v[96:111]
    ds_read_b64_tr_b16 a[156:157], v21 offset:32768
    ds_read_b64_tr_b16 a[158:159], v21 offset:33280
    s_add_u32 s4, s11, 1
    s_and_b32 s4, s4, 7
    v_mfma_f32_32x32x16_bf16 v[112:127], a[168:171], a[144:147], v[112:127]
    ds_read_b64_tr_b16 a[160:161], v21 offset:40960
    ds_read_b64_tr_b16 a[162:163], v21 offset:41472
    buffer_load_dwordx4 v5, s[24:27], s68 offen offset:1024  lds
    s_lshl_b32 s19, s4, 11
    s_add_u32 s4, s11, 2
    v_mfma_f32_32x32x16_bf16 v[128:143], a[172:175], a[44:47], v[128:143]
    s_bfe_u32 s5, s4, 0x20001
    s_add_u32 s5, s5, s12
    v_mfma_f32_32x32x16_bf16 v[144:159], a[172:175], a[144:147], v[144:159]
    s_lshl_b32 s7, s5, 1
    s_lshr_b32 s7, 0x3aaa4000, s7
    s_and_b32 s7, s7, 3
    s_waitcnt lgkmcnt(0)
    v_mfma_f32_32x32x16_bf16 v[64:79], a[152:155], a[48:51], v[64:79]
    ds_read_b128 a[52:55], v13 offset:49152
    ds_read_b64_tr_b16 a[164:165], v23 offset:24576
    buffer_load_dwordx4 v6, s[24:27], s68 offen offset:2048  lds
    s_mul_i32 s6, s5, 3
    s_sub_u32 s6, s6, s7
    v_mov_b32 v160, -1
    v_mov_b32 v161, -1
    v_mov_b32 v162, -1
    v_mov_b32 v163, -1
    v_mfma_f32_32x32x16_bf16 v[80:95], a[152:155], a[140:143], v[80:95]
    ds_read_b64_tr_b16 a[166:167], v23 offset:25088
    ds_read_b128 a[144:147], v17 offset:49152
    s_min_u32 s6, s6, 41
    v_mfma_f32_16x16x32_bf16 v[44:47], a[152:155], a[128:131], v[44:47]
    s_and_b32 s4, s4, 1
    s_add_u32 s4, s4, s6
    v_mfma_f32_32x32x16_bf16 v[96:111], a[156:159], a[48:51], v[96:111]
    ds_read_b64_tr_b16 a[168:169], v23 offset:32768
    ds_read_b64_tr_b16 a[170:171], v23 offset:33280
    buffer_load_dwordx4 v7, s[24:27], s68 offen offset:3072  lds
    s_lshl_b32 s96, s4, 15
    s_add_u32 s4, s11, 2
    v_mfma_f32_32x32x16_bf16 v[112:127], a[156:159], a[140:143], v[112:127]
    ds_read_b64_tr_b16 a[172:173], v23 offset:40960
    ds_read_b64_tr_b16 a[174:175], v23 offset:41472
    v_mfma_f32_16x16x32_bf16 v[44:47], a[156:159], a[132:135], v[44:47]
    s_and_b32 s4, s4, 7
    s_lshl_b32 s20, s4, 11
    v_mfma_f32_32x32x16_bf16 v[128:143], a[160:163], a[48:51], v[128:143]
    s_add_u32 s4, s11, 3
    s_bfe_u32 s5, s4, 0x20001
    s_add_u32 s5, s5, s12
    v_mfma_f32_32x32x16_bf16 v[144:159], a[160:163], a[140:143], v[144:159]
    s_add_u32 m0, s72, 24576
    s_mul_i32 s69, s85, 196608
    buffer_load_dwordx4 v8, s[28:31], s69 offen  lds
    v_mfma_f32_16x16x32_bf16 v[44:47], a[160:163], a[136:139], v[44:47]
    s_lshl_b32 s7, s5, 1
    s_lshr_b32 s7, 0x3aaa4000, s7
    s_waitcnt lgkmcnt(0)
    v_mfma_f32_32x32x16_bf16 v[64:79], a[164:167], a[52:55], v[64:79]
    ds_read_b128 a[56:59], v14 offset:49152
    ds_read_b64_tr_b16 a[152:153], v25 offset:24576
    s_and_b32 s7, s7, 3
    s_mul_i32 s6, s5, 3
    s_sub_u32 s6, s6, s7
    v_mfma_f32_32x32x16_bf16 v[80:95], a[164:167], a[144:147], v[80:95]
    ds_read_b64_tr_b16 a[154:155], v25 offset:25088
    ds_read_b128 a[140:143], v18 offset:49152
    buffer_load_dwordx4 v9, s[28:31], s69 offen offset:1024  lds
    s_add_u32 m0, s72, 32768
    v_mfma_f32_16x16x32_bf16 v[44:47], a[164:167], a[128:131], v[44:47]
    s_min_u32 s6, s6, 41
    s_and_b32 s4, s4, 1
    v_mfma_f32_32x32x16_bf16 v[96:111], a[168:171], a[52:55], v[96:111]
    ds_read_b64_tr_b16 a[156:157], v25 offset:32768
    ds_read_b64_tr_b16 a[158:159], v25 offset:33280
    s_add_u32 s4, s4, s6
    s_lshl_b32 s97, s4, 15
    v_mfma_f32_32x32x16_bf16 v[112:127], a[168:171], a[144:147], v[112:127]
    ds_read_b64_tr_b16 a[160:161], v25 offset:40960
    ds_read_b64_tr_b16 a[162:163], v25 offset:41472
    s_mul_i32 s70, s85, 176128
    buffer_load_dwordx4 v10, s[32:35], s70 offen  lds
    s_add_u32 s4, s11, 3
    v_mfma_f32_16x16x32_bf16 v[44:47], a[168:171], a[132:135], v[44:47]
    s_and_b32 s4, s4, 7
    s_lshl_b32 s21, s4, 11
    v_mfma_f32_32x32x16_bf16 v[128:143], a[172:175], a[52:55], v[128:143]
    s_add_u32 s4, s11, 4
    s_bfe_u32 s5, s4, 0x20001
    v_mfma_f32_32x32x16_bf16 v[144:159], a[172:175], a[144:147], v[144:159]
    buffer_load_dwordx4 v11, s[32:35], s70 offen offset:1024  lds
    s_add_u32 m0, s72, 40960
    s_add_u32 s5, s5, s12
    v_mfma_f32_16x16x32_bf16 v[44:47], a[172:175], a[136:139], v[44:47]
    s_lshl_b32 s7, s5, 1
    s_lshr_b32 s7, 0x3aaa4000, s7
    s_waitcnt lgkmcnt(0)
    v_mfma_f32_32x32x16_bf16 v[64:79], a[152:155], a[56:59], v[64:79]
    ds_read_b128 a[60:63], v15 offset:49152
    ds_read_b64_tr_b16 a[164:165], v27 offset:24576
    s_and_b32 s7, s7, 3
    s_mul_i32 s6, s5, 3
    v_mfma_f32_32x32x16_bf16 v[80:95], a[152:155], a[140:143], v[80:95]
    ds_read_b64_tr_b16 a[166:167], v27 offset:25088
    ds_read_b128 a[144:147], v19 offset:49152
    s_sub_u32 s6, s6, s7
    s_min_u32 s6, s6, 41
    s_and_b32 s4, s4, 1
    v_mfma_f32_32x32x16_bf16 v[96:111], a[156:159], a[56:59], v[96:111]
    ds_read_b64_tr_b16 a[168:169], v27 offset:32768
    ds_read_b64_tr_b16 a[170:171], v27 offset:33280
    buffer_load_dwordx4 v10, s[36:39], s70 offen  lds
    s_add_u32 s4, s4, s6
    s_lshl_b32 s98, s4, 15
    v_mfma_f32_32x32x16_bf16 v[112:127], a[156:159], a[140:143], v[112:127]
    ds_read_b64_tr_b16 a[172:173], v27 offset:40960
    ds_read_b64_tr_b16 a[174:175], v27 offset:41472
    s_add_u32 s4, s11, 4
    s_and_b32 s4, s4, 7
    v_mfma_f32_32x32x16_bf16 v[128:143], a[160:163], a[56:59], v[128:143]
    buffer_load_dwordx4 v11, s[36:39], s70 offen offset:1024  lds
    s_lshl_b32 s22, s4, 11
    s_add_u32 s4, s11, 5
    v_mfma_f32_32x32x16_bf16 v[144:159], a[160:163], a[140:143], v[144:159]
    s_bfe_u32 s5, s4, 0x20001
    s_add_u32 s5, s5, s12
    s_waitcnt lgkmcnt(0)
    s_waitcnt vmcnt(11)
    s_barrier
    v_mfma_f32_32x32x16_bf16 v[64:79], a[164:167], a[60:63], v[64:79]
    ds_read_b128 a[64:67], v12 offset:0
    ds_read_b64_tr_b16 a[152:153], v20 offset:0
    s_lshl_b32 s7, s5, 1
    s_lshr_b32 s7, 0x3aaa4000, s7
    v_mfma_f32_32x32x16_bf16 v[80:95], a[164:167], a[144:147], v[80:95]
    ds_read_b64_tr_b16 a[154:155], v20 offset:512
    ds_read_b128 a[140:143], v16 offset:0
    s_bfe_u32 s85, s83, 196632
    s_add_u32 m0, s71, 32768
    s_lshl_b32 s68, s85, 7
    buffer_load_dwordx4 v4, s[24:27], s68 offen  lds
    s_and_b32 s7, s7, 3
    s_mul_i32 s6, s5, 3
    v_mfma_f32_32x32x16_bf16 v[96:111], a[168:171], a[60:63], v[96:111]
    ds_read_b64_tr_b16 a[156:157], v20 offset:8192
    ds_read_b64_tr_b16 a[158:159], v20 offset:8704
    s_sub_u32 s6, s6, s7
    s_min_u32 s6, s6, 41
    v_mfma_f32_32x32x16_bf16 v[112:127], a[168:171], a[144:147], v[112:127]
    ds_read_b64_tr_b16 a[160:161], v20 offset:16384
    ds_read_b64_tr_b16 a[162:163], v20 offset:16896
    buffer_load_dwordx4 v5, s[24:27], s68 offen offset:1024  lds
    s_and_b32 s4, s4, 1
    s_add_u32 s4, s4, s6
    v_mfma_f32_32x32x16_bf16 v[128:143], a[172:175], a[60:63], v[128:143]
    s_lshl_b32 s99, s4, 15
    s_add_u32 s4, s11, 5
    s_and_b32 s4, s4, 7
    v_mfma_f32_32x32x16_bf16 v[144:159], a[172:175], a[144:147], v[144:159]
    s_lshl_b32 s23, s4, 11
    s_add_u32 s4, s11, 6
    s_waitcnt lgkmcnt(0)
    v_mfma_f32_32x32x16_bf16 v[64:79], a[152:155], a[64:67], v[64:79]
    ds_read_b128 a[68:71], v13 offset:0
    ds_read_b64_tr_b16 a[164:165], v22 offset:0
    buffer_load_dwordx4 v6, s[24:27], s68 offen offset:2048  lds
    s_bfe_u32 s5, s4, 0x20001
    s_add_u32 s5, s5, s12
    v_mfma_f32_32x32x16_bf16 v[80:95], a[152:155], a[140:143], v[80:95]
    ds_read_b64_tr_b16 a[166:167], v22 offset:512
    ds_read_b128 a[144:147], v17 offset:0
    s_lshl_b32 s7, s5, 1
    v_mfma_f32_16x16x32_bf16 v[44:47], a[152:155], a[128:131], v[44:47]
    s_lshr_b32 s7, 0x3aaa4000, s7
    s_and_b32 s7, s7, 3
    v_mfma_f32_32x32x16_bf16 v[96:111], a[156:159], a[64:67], v[96:111]
    ds_read_b64_tr_b16 a[168:169], v22 offset:8192
    ds_read_b64_tr_b16 a[170:171], v22 offset:8704
    buffer_load_dwordx4 v7, s[24:27], s68 offen offset:3072  lds
    s_mul_i32 s6, s5, 3
    s_sub_u32 s6, s6, s7
    v_mfma_f32_32x32x16_bf16 v[112:127], a[156:159], a[140:143], v[112:127]
    ds_read_b64_tr_b16 a[172:173], v22 offset:16384
    ds_read_b64_tr_b16 a[174:175], v22 offset:16896
    s_min_u32 s6, s6, 41
    v_mfma_f32_16x16x32_bf16 v[44:47], a[156:159], a[132:135], v[44:47]
    s_and_b32 s4, s4, 1
    s_add_u32 s4, s4, s6
    v_mfma_f32_32x32x16_bf16 v[128:143], a[160:163], a[64:67], v[128:143]
    s_lshl_b32 s100, s4, 15
    s_add_u32 s4, s11, 6
    v_mfma_f32_32x32x16_bf16 v[144:159], a[160:163], a[140:143], v[144:159]
    s_add_u32 m0, s72, 49152
    s_mul_i32 s69, s85, 196608
    buffer_load_dwordx4 v8, s[28:31], s69 offen  lds
    s_and_b32 s4, s4, 7
    v_mfma_f32_16x16x32_bf16 v[44:47], a[160:163], a[136:139], v[44:47]
    s_lshl_b32 s92, s4, 11
    s_add_u32 s4, s11, 7
    s_waitcnt lgkmcnt(0)
    v_mfma_f32_32x32x16_bf16 v[64:79], a[164:167], a[68:71], v[64:79]
    ds_read_b128 a[72:75], v14 offset:0
    ds_read_b64_tr_b16 a[152:153], v24 offset:0
    s_bfe_u32 s5, s4, 0x20001
    s_add_u32 s5, s5, s12
    v_mfma_f32_32x32x16_bf16 v[80:95], a[164:167], a[144:147], v[80:95]
    ds_read_b64_tr_b16 a[154:155], v24 offset:512
    ds_read_b128 a[140:143], v18 offset:0
    buffer_load_dwordx4 v9, s[28:31], s69 offen offset:1024  lds
    s_add_u32 m0, s72, 57344
    v_mfma_f32_16x16x32_bf16 v[44:47], a[164:167], a[128:131], v[44:47]
    s_lshl_b32 s7, s5, 1
    s_lshr_b32 s7, 0x3aaa4000, s7
    v_mfma_f32_32x32x16_bf16 v[96:111], a[168:171], a[68:71], v[96:111]
    ds_read_b64_tr_b16 a[156:157], v24 offset:8192
    ds_read_b64_tr_b16 a[158:159], v24 offset:8704
    s_and_b32 s7, s7, 3
    s_mul_i32 s6, s5, 3
    s_sub_u32 s6, s6, s7
    v_mfma_f32_32x32x16_bf16 v[112:127], a[168:171], a[144:147], v[112:127]
    ds_read_b64_tr_b16 a[160:161], v24 offset:16384
    ds_read_b64_tr_b16 a[162:163], v24 offset:16896
    s_mul_i32 s70, s85, 176128
    buffer_load_dwordx4 v10, s[32:35], s70 offen  lds
    v_mfma_f32_16x16x32_bf16 v[44:47], a[168:171], a[132:135], v[44:47]
    s_min_u32 s6, s6, 41
    s_and_b32 s4, s4, 1
    v_mfma_f32_32x32x16_bf16 v[128:143], a[172:175], a[68:71], v[128:143]
    s_add_u32 s4, s4, s6
    s_lshl_b32 s101, s4, 15
    s_add_u32 s4, s11, 7
    v_mfma_f32_32x32x16_bf16 v[144:159], a[172:175], a[144:147], v[144:159]
    buffer_load_dwordx4 v11, s[32:35], s70 offen offset:1024  lds
    s_add_u32 m0, s72, 65536
    v_mfma_f32_16x16x32_bf16 v[44:47], a[172:175], a[136:139], v[44:47]
    s_and_b32 s4, s4, 7
    s_lshl_b32 s93, s4, 11
    s_waitcnt lgkmcnt(0)
    v_mfma_f32_32x32x16_bf16 v[64:79], a[152:155], a[72:75], v[64:79]
    ds_read_b128 a[76:79], v15 offset:0
    ds_read_b64_tr_b16 a[164:165], v26 offset:0
    s_add_u32 s4, s62, s63
    s_mul_i32 s5, s4, 43
    s_lshr_b32 s5, s5, 7
    v_mfma_f32_32x32x16_bf16 v[80:95], a[152:155], a[140:143], v[80:95]
    ds_read_b64_tr_b16 a[166:167], v26 offset:512
    ds_read_b128 a[144:147], v19 offset:0
    s_mul_i32 s5, s5, 3
    s_sub_u32 s4, s4, s5
    v_mfma_f32_32x32x16_bf16 v[96:111], a[156:159], a[72:75], v[96:111]
    ds_read_b64_tr_b16 a[168:169], v26 offset:8192
    ds_read_b64_tr_b16 a[170:171], v26 offset:8704
    buffer_load_dwordx4 v10, s[36:39], s70 offen  lds
    s_and_b32 s4, s4, 3
    s_mul_i32 s6, s3, 10240
    v_mfma_f32_32x32x16_bf16 v[112:127], a[156:159], a[140:143], v[112:127]
    ds_read_b64_tr_b16 a[172:173], v26 offset:16384
    ds_read_b64_tr_b16 a[174:175], v26 offset:16896
    s_sub_u32 s6, 65536, s6
    s_mul_i32 s7, s3, 9
    v_mfma_f32_32x32x16_bf16 v[128:143], a[160:163], a[72:75], v[128:143]
    buffer_load_dwordx4 v11, s[36:39], s70 offen offset:1024  lds
    s_lshr_b32 s5, s3, 1
    s_lshl_b32 s5, s5, 2
    v_mfma_f32_32x32x16_bf16 v[144:159], a[160:163], a[140:143], v[144:159]
    buffer_load_dword v58, v228, s[52:55], 0 offen sc1
    s_add_u32 s7, s7, s5
    s_add_u32 s7, s7, 2
    s_waitcnt lgkmcnt(0)
    s_waitcnt vmcnt(11)
    s_barrier
    v_mfma_f32_32x32x16_bf16 v[64:79], a[164:167], a[76:79], v[64:79]
    ds_read_b128 a[80:83], v12 offset:16384
    ds_read_b64_tr_b16 a[152:153], v20 offset:24576
    s_lshl_b32 s7, s7, 15
    s_lshl_b32 s5, s4, 11
    v_mfma_f32_32x32x16_bf16 v[80:95], a[164:167], a[144:147], v[80:95]
    ds_read_b64_tr_b16 a[154:155], v20 offset:25088
    ds_read_b128 a[140:143], v16 offset:16384
    s_bfe_u32 s85, s83, 196636
    s_add_u32 m0, s71, 49152
    s_lshl_b32 s68, s85, 7
    buffer_load_dwordx4 v4, s[24:27], s68 offen  lds
    s_add_u32 s64, s5, s6
    s_mul_i32 s5, s4, 98304
    v_mfma_f32_32x32x16_bf16 v[96:111], a[168:171], a[76:79], v[96:111]
    ds_read_b64_tr_b16 a[156:157], v20 offset:32768
    ds_read_b64_tr_b16 a[158:159], v20 offset:33280
    s_add_u32 s17, s5, s7
    s_add_u32 s4, s4, 1
    v_mfma_f32_32x32x16_bf16 v[112:127], a[168:171], a[144:147], v[112:127]
    ds_read_b64_tr_b16 a[160:161], v20 offset:40960
    ds_read_b64_tr_b16 a[162:163], v20 offset:41472
    buffer_load_dwordx4 v5, s[24:27], s68 offen offset:1024  lds
    s_cmp_eq_u32 s4, 3
    s_cselect_b32 s4, 0, s4
    s_lshl_b32 s5, s4, 11
    v_mfma_f32_32x32x16_bf16 v[128:143], a[172:175], a[76:79], v[128:143]
    s_add_u32 s65, s5, s6
    s_mul_i32 s5, s4, 98304
    v_mfma_f32_32x32x16_bf16 v[144:159], a[172:175], a[144:147], v[144:159]
    s_add_u32 s14, s5, s7
    s_add_u32 s4, s4, 1
    s_waitcnt lgkmcnt(0)
    v_mfma_f32_32x32x16_bf16 v[64:79], a[152:155], a[80:83], v[64:79]
    ds_read_b128 a[84:87], v13 offset:16384
    ds_read_b64_tr_b16 a[164:165], v22 offset:24576
    buffer_load_dwordx4 v6, s[24:27], s68 offen offset:2048  lds
    s_cmp_eq_u32 s4, 3
    s_cselect_b32 s4, 0, s4
    v_mfma_f32_32x32x16_bf16 v[80:95], a[152:155], a[140:143], v[80:95]
    ds_read_b64_tr_b16 a[166:167], v22 offset:25088
    ds_read_b128 a[144:147], v17 offset:16384
    s_lshl_b32 s5, s4, 11
    v_mfma_f32_16x16x32_bf16 v[44:47], a[152:155], a[128:131], v[44:47]
    s_add_u32 s16, s5, s6
    s_mul_i32 s5, s4, 98304
    v_mfma_f32_32x32x16_bf16 v[96:111], a[156:159], a[80:83], v[96:111]
    ds_read_b64_tr_b16 a[168:169], v22 offset:32768
    ds_read_b64_tr_b16 a[170:171], v22 offset:33280
    buffer_load_dwordx4 v7, s[24:27], s68 offen offset:3072  lds
    s_add_u32 s15, s5, s7
    s_add_u32 s4, s4, 1
    v_mfma_f32_32x32x16_bf16 v[112:127], a[156:159], a[140:143], v[112:127]
    ds_read_b64_tr_b16 a[172:173], v22 offset:40960
    ds_read_b64_tr_b16 a[174:175], v22 offset:41472
    s_cmp_eq_u32 s4, 3
    s_cselect_b32 s4, 0, s4
    v_mfma_f32_16x16x32_bf16 v[44:47], a[156:159], a[132:135], v[44:47]
    s_lshl_b32 s87, s11, 11
    v_mfma_f32_32x32x16_bf16 v[128:143], a[160:163], a[80:83], v[128:143]
    s_lshl_b32 s12, s11, 14
    s_lshl_b32 s13, s11, 10
    v_mfma_f32_32x32x16_bf16 v[144:159], a[160:163], a[140:143], v[144:159]
    s_add_u32 m0, s72, 73728
    s_mul_i32 s69, s85, 196608
    buffer_load_dwordx4 v8, s[28:31], s69 offen  lds
    v_lshrrev_b32 v192, 3, v0
    v_mfma_f32_16x16x32_bf16 v[44:47], a[160:163], a[136:139], v[44:47]
    v_and_b32 v193, 7, v0
    s_lshl_b32 s4, s62, 6
    s_waitcnt lgkmcnt(0)
    v_mfma_f32_32x32x16_bf16 v[64:79], a[164:167], a[84:87], v[64:79]
    ds_read_b128 a[88:91], v14 offset:16384
    ds_read_b64_tr_b16 a[152:153], v24 offset:24576
    s_lshl_b32 s5, s3, 3
    s_add_u32 s4, s4, s5
    v_mfma_f32_32x32x16_bf16 v[80:95], a[164:167], a[144:147], v[80:95]
    ds_read_b64_tr_b16 a[154:155], v24 offset:25088
    ds_read_b128 a[140:143], v18 offset:16384
    buffer_load_dwordx4 v9, s[28:31], s69 offen offset:1024  lds
    s_add_u32 m0, s72, 81920
    s_lshl_b32 s4, s4, 10
    v_mfma_f32_16x16x32_bf16 v[44:47], a[164:167], a[128:131], v[44:47]
    s_lshl_b32 s5, s63, 7
    s_add_u32 s4, s4, s5
    v_mfma_f32_32x32x16_bf16 v[96:111], a[168:171], a[84:87], v[96:111]
    ds_read_b64_tr_b16 a[156:157], v24 offset:32768
    ds_read_b64_tr_b16 a[158:159], v24 offset:33280
    v_lshlrev_b32 v194, 10, v192
    v_lshl_add_u32 v194, v193, 4, v194
    v_mfma_f32_32x32x16_bf16 v[112:127], a[168:171], a[144:147], v[112:127]
    ds_read_b64_tr_b16 a[160:161], v24 offset:40960
    ds_read_b64_tr_b16 a[162:163], v24 offset:41472
    s_mul_i32 s70, s85, 176128
    buffer_load_dwordx4 v10, s[32:35], s70 offen  lds
    v_add_u32 v194, s4, v194
    v_mfma_f32_16x16x32_bf16 v[44:47], a[168:171], a[132:135], v[44:47]
    v_mov_b32 v217, v194
    v_add_u32 v194, 32768, v194
    v_mfma_f32_32x32x16_bf16 v[128:143], a[172:175], a[84:87], v[128:143]
    v_mov_b32 v218, v194
    v_lshlrev_b32 v193, 1, v193
    v_mfma_f32_32x32x16_bf16 v[144:159], a[172:175], a[144:147], v[144:159]
    buffer_load_dwordx4 v11, s[32:35], s70 offen offset:1024  lds
    s_add_u32 m0, s72, 90112
    v_xor_b32 v193, v193, v192
    v_mfma_f32_16x16x32_bf16 v[44:47], a[172:175], a[136:139], v[44:47]
    v_lshlrev_b32 v192, 8, v192
    v_lshl_add_u32 v192, v193, 4, v192
    s_waitcnt lgkmcnt(0)
    v_mfma_f32_32x32x16_bf16 v[64:79], a[152:155], a[88:91], v[64:79]
    ds_read_b128 a[92:95], v15 offset:16384
    ds_read_b64_tr_b16 a[164:165], v26 offset:24576
    s_lshl_b32 s4, s3, 11
    v_add_u32 v192, s4, v192
    v_mfma_f32_32x32x16_bf16 v[80:95], a[152:155], a[140:143], v[80:95]
    ds_read_b64_tr_b16 a[166:167], v26 offset:25088
    ds_read_b128 a[144:147], v19 offset:16384
    v_mov_b32 v227, v192
    v_and_b32 v192, 31, v0
    v_mfma_f32_32x32x16_bf16 v[96:111], a[156:159], a[88:91], v[96:111]
    ds_read_b64_tr_b16 a[168:169], v26 offset:32768
    ds_read_b64_tr_b16 a[170:171], v26 offset:33280
    buffer_load_dwordx4 v10, s[36:39], s70 offen  lds
    v_lshrrev_b32 v193, 5, v0
    v_and_b32 v194, 7, v0
    v_mfma_f32_32x32x16_bf16 v[112:127], a[156:159], a[140:143], v[112:127]
    ds_read_b64_tr_b16 a[172:173], v26 offset:40960
    ds_read_b64_tr_b16 a[174:175], v26 offset:41472
    v_xor_b32 v193, v193, v194
    v_lshlrev_b32 v192, 8, v192
    v_mfma_f32_32x32x16_bf16 v[128:143], a[160:163], a[88:91], v[128:143]
    buffer_load_dwordx4 v11, s[36:39], s70 offen offset:1024  lds
    v_lshl_add_u32 v192, v193, 4, v192
    s_lshl_b32 s4, s3, 14
    v_mfma_f32_32x32x16_bf16 v[144:159], a[160:163], a[140:143], v[144:159]
    v_add_u32 v192, s4, v192
    v_mov_b32 v226, v192
    s_waitcnt lgkmcnt(0)
    s_waitcnt vmcnt(11)
    s_barrier
    v_mfma_f32_32x32x16_bf16 v[64:79], a[164:167], a[92:95], v[64:79]
    ds_read_b128 a[96:99], v12 offset:32768
    ds_read_b64_tr_b16 a[152:153], v21 offset:0
    v_add_u32 v192, s71, v52
    v_mov_b32 v208, v192
    v_mfma_f32_32x32x16_bf16 v[80:95], a[164:167], a[144:147], v[80:95]
    ds_read_b64_tr_b16 a[154:155], v21 offset:512
    ds_read_b128 a[140:143], v16 offset:32768
    v_lshrrev_b32 v193, 5, v0
    v_bfe_u32 v194, v0, 2, 2
    s_waitcnt vmcnt(10)
    v_cmp_eq_u32 vcc, 0, v58
    s_nop 0
    s_cbranch_vccnz L_spin_st
L_ok_st:
    v_mfma_f32_32x32x16_bf16 v[96:111], a[168:171], a[92:95], v[96:111]
    ds_read_b64_tr_b16 a[156:157], v21 offset:8192
    ds_read_b64_tr_b16 a[158:159], v21 offset:8704
    buffer_load_dwordx2 v[176:177], v61, s[52:55], s1 offen offset:0 sc1
    v_lshl_add_u32 v194, v193, 2, v194
    v_lshlrev_b32 v194, 5, v194
    v_and_b32 v192, 1, v0
    v_mfma_f32_32x32x16_bf16 v[112:127], a[168:171], a[144:147], v[112:127]
    ds_read_b64_tr_b16 a[160:161], v21 offset:16384
    ds_read_b64_tr_b16 a[162:163], v21 offset:16896
    buffer_load_dwordx2 v[178:179], v61, s[52:55], s1 offen offset:512 sc1
    v_lshl_add_u32 v194, v192, 4, v194
    v_bfe_u32 v192, v0, 1, 1
    v_mfma_f32_32x32x16_bf16 v[128:143], a[172:175], a[92:95], v[128:143]
    buffer_load_dwordx2 v[180:181], v61, s[52:55], s1 offen offset:1024 sc1
    v_lshl_add_u32 v194, v192, 3, v194
    s_add_u32 s4, s71, 2048
    v_mfma_f32_32x32x16_bf16 v[144:159], a[172:175], a[144:147], v[144:159]
    buffer_load_dwordx2 v[182:183], v61, s[52:55], s1 offen offset:1536 sc1
    v_add_u32 v194, s4, v194
    v_xor_b32 v193, 1, v193
    s_waitcnt lgkmcnt(0)
    v_mfma_f32_32x32x16_bf16 v[64:79], a[152:155], a[96:99], v[64:79]
    ds_read_b128 a[100:103], v13 offset:32768
    ds_read_b64_tr_b16 a[164:165], v23 offset:0
    v_lshlrev_b32 v193, 7, v193
    s_lshl_b32 s4, s3, 3
    v_mfma_f32_32x32x16_bf16 v[80:95], a[152:155], a[140:143], v[80:95]
    ds_read_b64_tr_b16 a[166:167], v23 offset:512
    ds_read_b128 a[144:147], v17 offset:32768
    s_add_u32 s4, s4, 49152
    v_mfma_f32_16x16x32_bf16 v[44:47], a[152:155], a[128:131], v[44:47]
    v_add_u32 v196, 49272, v193
    v_add_u32 v193, s4, v193
    v_mfma_f32_32x32x16_bf16 v[96:111], a[156:159], a[96:99], v[96:111]
    ds_read_b64_tr_b16 a[168:169], v23 offset:8192
    ds_read_b64_tr_b16 a[170:171], v23 offset:8704
    v_and_b32 v192, 2, v0
    v_mfma_f32_32x32x16_bf16 v[112:127], a[156:159], a[140:143], v[112:127]
    ds_read_b64_tr_b16 a[172:173], v23 offset:16384
    ds_read_b64_tr_b16 a[174:175], v23 offset:16896
    v_cmp_eq_u32 vcc, 0, v192
    s_nop 1
    v_cndmask_b32 v193, v196, v193, vcc
    v_cndmask_b32 v196, 0, 8, vcc
    v_mfma_f32_16x16x32_bf16 v[44:47], a[156:159], a[132:135], v[44:47]
    v_and_b32 v192, 16, v0
    v_mfma_f32_32x32x16_bf16 v[128:143], a[160:163], a[96:99], v[128:143]
    v_mfma_f32_32x32x16_bf16 v[144:159], a[160:163], a[140:143], v[144:159]
    v_cmp_eq_u32 vcc, 0, v192
    s_nop 1
    v_cndmask_b32 v192, v193, v194, vcc
    v_mov_b32 v209, v192
    v_mov_b32 v194, 4096
    v_cndmask_b32 v192, v196, v194, vcc
    v_mfma_f32_16x16x32_bf16 v[44:47], a[160:163], a[136:139], v[44:47]
    s_waitcnt lgkmcnt(0)
    v_mfma_f32_32x32x16_bf16 v[64:79], a[164:167], a[100:103], v[64:79]
    ds_read_b128 a[104:107], v14 offset:32768
    ds_read_b64_tr_b16 a[152:153], v25 offset:0
    v_mov_b32 v210, v192
    s_lshl_b32 s4, s67, 15
    v_mfma_f32_32x32x16_bf16 v[80:95], a[164:167], a[144:147], v[80:95]
    ds_read_b64_tr_b16 a[154:155], v25 offset:512
    ds_read_b128 a[140:143], v18 offset:32768
    s_bfe_u32 s85, s84, 196608
    s_add_u32 m0, s72, 0
    s_mul_i32 s69, s85, 196608
    buffer_load_dwordx4 v28, s[28:31], s69 offen  lds
    s_lshl_b32 s5, s61, 11
    v_mfma_f32_16x16x32_bf16 v[44:47], a[164:167], a[128:131], v[44:47]
    s_add_u32 s4, s4, s5
    s_add_u32 s4, s4, 10485760
    v_mfma_f32_32x32x16_bf16 v[96:111], a[168:171], a[100:103], v[96:111]
    ds_read_b64_tr_b16 a[156:157], v25 offset:8192
    ds_read_b64_tr_b16 a[158:159], v25 offset:8704
    buffer_load_dwordx4 v29, s[28:31], s69 offen offset:1024  lds
    s_add_u32 m0, s72, 8192
    v_add_u32 v192, s4, v52
    v_mov_b32 v211, v192
    v_mfma_f32_32x32x16_bf16 v[112:127], a[168:171], a[144:147], v[112:127]
    ds_read_b64_tr_b16 a[160:161], v25 offset:16384
    ds_read_b64_tr_b16 a[162:163], v25 offset:16896
    s_lshl_b32 s4, s61, 18
    v_mfma_f32_16x16x32_bf16 v[44:47], a[168:171], a[132:135], v[44:47]
    v_add_u32 v192, s4, v52
    v_mov_b32 v212, v192
    v_mfma_f32_32x32x16_bf16 v[128:143], a[172:175], a[100:103], v[128:143]
    s_mul_i32 s70, s85, 176128
    buffer_load_dwordx4 v30, s[32:35], s70 offen  lds
    s_add_i32 s4, s67, 0
    s_lshl_b32 s8, s4, 12
    v_mfma_f32_32x32x16_bf16 v[144:159], a[172:175], a[144:147], v[144:159]
    s_cmp_lt_i32 s4, 0
    s_cselect_b32 s8, s86, s8
    v_mfma_f32_16x16x32_bf16 v[44:47], a[172:175], a[136:139], v[44:47]
    s_add_i32 s4, s67, -4
    s_waitcnt lgkmcnt(0)
    v_mfma_f32_32x32x16_bf16 v[64:79], a[152:155], a[104:107], v[64:79]
    ds_read_b128 a[108:111], v15 offset:32768
    ds_read_b64_tr_b16 a[164:165], v27 offset:0
    buffer_load_dwordx4 v31, s[32:35], s70 offen offset:1024  lds
    s_add_u32 m0, s72, 16384
    s_lshl_b32 s9, s4, 12
    v_mfma_f32_32x32x16_bf16 v[80:95], a[152:155], a[140:143], v[80:95]
    ds_read_b64_tr_b16 a[166:167], v27 offset:512
    ds_read_b128 a[144:147], v19 offset:32768
    s_cmp_lt_i32 s4, 0
    s_cselect_b32 s9, s86, s9
    s_add_i32 s4, s67, -8
    v_mfma_f32_32x32x16_bf16 v[96:111], a[156:159], a[104:107], v[96:111]
    ds_read_b64_tr_b16 a[168:169], v27 offset:8192
    ds_read_b64_tr_b16 a[170:171], v27 offset:8704
    buffer_load_dwordx4 v30, s[36:39], s70 offen  lds
    s_lshl_b32 s10, s4, 12
    v_mfma_f32_32x32x16_bf16 v[112:127], a[156:159], a[140:143], v[112:127]
    ds_read_b64_tr_b16 a[172:173], v27 offset:16384
    ds_read_b64_tr_b16 a[174:175], v27 offset:16896
    s_cmp_lt_i32 s4, 0
    s_cselect_b32 s10, s86, s10
    v_min_u32 v193, 5, v0
    v_mfma_f32_32x32x16_bf16 v[128:143], a[160:163], a[104:107], v[128:143]
    buffer_load_dwordx4 v31, s[36:39], s70 offen offset:1024  lds
    v_lshrrev_b32 v194, 1, v193
    v_lshlrev_b32 v194, 2, v194
    v_mfma_f32_32x32x16_bf16 v[144:159], a[160:163], a[140:143], v[144:159]
    v_sub_u32 v194, s67, v194
    s_waitcnt lgkmcnt(0)
    s_waitcnt vmcnt(10)
    s_barrier
    v_mfma_f32_32x32x16_bf16 v[64:79], a[164:167], a[108:111], v[64:79]
    ds_read_b128 a[112:115], v12 offset:49152
    ds_read_b64_tr_b16 a[152:153], v21 offset:24576
    v_cmp_gt_i32 vcc, 0, v194
    v_mov_b32 v192, s67
    s_nop 0
    v_cndmask_b32 v194, v194, v192, vcc
    v_mfma_f32_32x32x16_bf16 v[80:95], a[164:167], a[144:147], v[80:95]
    ds_read_b64_tr_b16 a[154:155], v21 offset:25088
    ds_read_b128 a[140:143], v16 offset:49152
    v_lshlrev_b32 v194, 7, v194
    v_and_b32 v193, 1, v193
    v_lshl_add_u32 v194, v193, 3, v194
    v_mfma_f32_32x32x16_bf16 v[96:111], a[168:171], a[108:111], v[96:111]
    ds_read_b64_tr_b16 a[156:157], v21 offset:32768
    ds_read_b64_tr_b16 a[158:159], v21 offset:33280
    s_bfe_u32 s85, s84, 196616
    s_add_u32 m0, s72, 24576
    s_mul_i32 s69, s85, 196608
    buffer_load_dwordx4 v28, s[28:31], s69 offen  lds
    s_and_b32 s4, s61, 14
    s_lshl_b32 s4, s4, 3
    v_mfma_f32_32x32x16_bf16 v[112:127], a[168:171], a[144:147], v[112:127]
    ds_read_b64_tr_b16 a[160:161], v21 offset:40960
    ds_read_b64_tr_b16 a[162:163], v21 offset:41472
    s_and_b32 s5, s61, 1
    s_lshl_b32 s5, s5, 2
    v_mfma_f32_32x32x16_bf16 v[128:143], a[172:175], a[108:111], v[128:143]
    s_add_u32 s4, s4, s5
    s_add_u32 s4, s4, 12582912
    v_mfma_f32_32x32x16_bf16 v[144:159], a[172:175], a[144:147], v[144:159]
    v_add_u32 v192, s4, v194
    v_mov_b32 v213, v192
    s_waitcnt lgkmcnt(0)
    v_mfma_f32_32x32x16_bf16 v[64:79], a[152:155], a[112:115], v[64:79]
    ds_read_b128 a[116:119], v13 offset:49152
    ds_read_b64_tr_b16 a[164:165], v23 offset:24576
    buffer_load_dwordx4 v29, s[28:31], s69 offen offset:1024  lds
    s_add_u32 m0, s72, 32768
    s_lshl_b32 s4, s62, 8
    s_add_u32 s4, s4, 12591104
    s_waitcnt vmcnt(10)
    v_add_f32 v176, v176, v178
    v_add_f32 v177, v177, v179
    v_mfma_f32_32x32x16_bf16 v[80:95], a[152:155], a[140:143], v[80:95]
    ds_read_b64_tr_b16 a[166:167], v23 offset:25088
    ds_read_b128 a[144:147], v17 offset:49152
    v_lshlrev_b32 v192, 2, v0
    v_add_u32 v192, s4, v192
    v_mov_b32 v214, v192
    s_waitcnt vmcnt(8)
    v_add_f32 v180, v180, v182
    v_mfma_f32_16x16x32_bf16 v[44:47], a[152:155], a[128:131], v[44:47]
    v_add_f32 v181, v181, v183
    v_add_f32 v176, v176, v180
    v_mfma_f32_32x32x16_bf16 v[96:111], a[156:159], a[112:115], v[96:111]
    ds_read_b64_tr_b16 a[168:169], v23 offset:32768
    ds_read_b64_tr_b16 a[170:171], v23 offset:33280
    v_add_f32 v177, v177, v181
    v_mul_f32 v40, 0xbb000000, v176
    v_mfma_f32_32x32x16_bf16 v[112:127], a[156:159], a[140:143], v[112:127]
    ds_read_b64_tr_b16 a[172:173], v23 offset:40960
    ds_read_b64_tr_b16 a[174:175], v23 offset:41472
    v_mul_f32 v177, 0x3b000000, v177
    v_mfma_f32_16x16x32_bf16 v[44:47], a[156:159], a[132:135], v[44:47]
    v_fma_f32 v177, -v40, v40, v177
    v_max_f32 v177, 0, v177
    v_mfma_f32_32x32x16_bf16 v[128:143], a[160:163], a[112:115], v[128:143]
    s_mul_i32 s70, s85, 176128
    buffer_load_dwordx4 v30, s[32:35], s70 offen  lds
    buffer_store_dwordx4 v[160:163], v211, s[52:55], 0 offen offset:0 sc1
    v_add_f32 v41, 0x3727c5ac, v177
    v_mov_b32 v42, v40
    v_mov_b32 v43, v41
    v_mfma_f32_32x32x16_bf16 v[144:159], a[160:163], a[140:143], v[144:159]
    s_nop 0
    v_mfma_f32_16x16x32_bf16 v[44:47], a[160:163], a[136:139], v[44:47]
    v_permlane32_swap_b32 v40, v42
    v_permlane32_swap_b32 v41, v43
    s_waitcnt lgkmcnt(0)
    v_mfma_f32_32x32x16_bf16 v[64:79], a[164:167], a[116:119], v[64:79]
    ds_read_b128 a[120:123], v14 offset:49152
    ds_read_b64_tr_b16 a[152:153], v25 offset:24576
    v_rsq_f32 v4, v41
    v_mfma_f32_32x32x16_bf16 v[80:95], a[164:167], a[144:147], v[80:95]
    ds_read_b64_tr_b16 a[154:155], v25 offset:25088
    ds_read_b128 a[140:143], v18 offset:49152
    buffer_load_dwordx4 v31, s[32:35], s70 offen offset:1024  lds
    s_add_u32 m0, s72, 40960
    v_mov_b32 v7, v41
    v_mfma_f32_16x16x32_bf16 v[44:47], a[164:167], a[128:131], v[44:47]
    v_mul_f32 v5, 0xc0135761, v4
    v_mul_f32 v232, v4, v4
    v_mfma_f32_32x32x16_bf16 v[96:111], a[168:171], a[116:119], v[96:111]
    ds_read_b64_tr_b16 a[156:157], v25 offset:32768
    ds_read_b64_tr_b16 a[158:159], v25 offset:33280
    v_mul_f32 v232, 0x3d372713, v232
    v_mul_f32 v6, v5, v232
    v_mfma_f32_32x32x16_bf16 v[112:127], a[168:171], a[144:147], v[112:127]
    ds_read_b64_tr_b16 a[160:161], v25 offset:40960
    ds_read_b64_tr_b16 a[162:163], v25 offset:41472
    v_mfma_f32_16x16x32_bf16 v[44:47], a[168:171], a[132:135], v[44:47]
    v_mul_f32 v229, 0x3eb8aa3b, v4
    v_rsq_f32 v8, v43
    v_mfma_f32_32x32x16_bf16 v[128:143], a[172:175], a[116:119], v[128:143]
    v_mov_b32 v11, v43
    v_mul_f32 v9, 0xc0135761, v8
    v_mfma_f32_32x32x16_bf16 v[144:159], a[172:175], a[144:147], v[144:159]
    buffer_load_dwordx4 v30, s[36:39], s70 offen  lds
    v_mul_f32 v232, v8, v8
    v_mfma_f32_16x16x32_bf16 v[44:47], a[172:175], a[136:139], v[44:47]
    v_mul_f32 v232, 0x3d372713, v232
    v_mul_f32 v10, v9, v232
    s_waitcnt lgkmcnt(0)
    v_mfma_f32_32x32x16_bf16 v[64:79], a[152:155], a[120:123], v[64:79]
    ds_read_b128 a[124:127], v15 offset:49152
    ds_read_b64_tr_b16 a[164:165], v27 offset:24576
    buffer_store_dwordx4 v[160:163], v211, s[52:55], 0 offen offset:1024 sc1
    s_nop 0
    v_cvt_pk_bf16_f32 v236, v44, v44
    v_and_b32 v237, 0xffff0000, v236
    v_sub_f32 v237, v44, v237
    v_cvt_pk_bf16_f32 v237, v237, v237
    v_mfma_f32_32x32x16_bf16 v[80:95], a[152:155], a[140:143], v[80:95]
    ds_read_b64_tr_b16 a[166:167], v27 offset:25088
    ds_read_b128 a[144:147], v19 offset:49152
    ds_write_b64 v56, v[236:237] offset:0
    v_cvt_pk_bf16_f32 v252, v45, v45
    v_and_b32 v253, 0xffff0000, v252
    v_sub_f32 v253, v45, v253
    v_mfma_f32_32x32x16_bf16 v[96:111], a[156:159], a[120:123], v[96:111]
    ds_read_b64_tr_b16 a[168:169], v27 offset:32768
    ds_read_b64_tr_b16 a[170:171], v27 offset:33280
    v_cvt_pk_bf16_f32 v253, v253, v253
    v_cvt_pk_bf16_f32 v236, v46, v46
    v_and_b32 v237, 0xffff0000, v236
    v_mfma_f32_32x32x16_bf16 v[112:127], a[156:159], a[140:143], v[112:127]
    ds_read_b64_tr_b16 a[172:173], v27 offset:40960
    ds_read_b64_tr_b16 a[174:175], v27 offset:41472
    ds_write_b64 v56, v[252:253] offset:8
    buffer_load_dwordx4 v31, s[36:39], s70 offen offset:1024  lds
    v_sub_f32 v237, v46, v237
    v_cvt_pk_bf16_f32 v237, v237, v237
    v_cvt_pk_bf16_f32 v252, v47, v47
    v_mfma_f32_32x32x16_bf16 v[128:143], a[160:163], a[120:123], v[128:143]
    ds_write_b64 v56, v[236:237] offset:16
    v_and_b32 v253, 0xffff0000, v252
    v_sub_f32 v253, v47, v253
    v_cvt_pk_bf16_f32 v253, v253, v253
    v_mfma_f32_32x32x16_bf16 v[144:159], a[160:163], a[140:143], v[144:159]
    ds_write_b64 v56, v[252:253] offset:24
    s_waitcnt lgkmcnt(9)
    v_mfma_f32_32x32x16_bf16 v[64:79], a[164:167], a[124:127], v[64:79]
    v_cvt_pk_bf16_f32 v232, v40, v40
    v_and_b32 v232, 0xffff0000, v232
    v_sub_f32 v233, v40, v232
    v_cvt_pk_bf16_f32 v12, v232, v233
    s_waitcnt lgkmcnt(8)
    v_mfma_f32_32x32x16_bf16 v[80:95], a[164:167], a[144:147], v[80:95]
    v_mov_b32 v13, v12
    v_mov_b32 v14, v12
    v_mov_b32 v15, v12
    s_waitcnt lgkmcnt(0)
    s_waitcnt vmcnt(8)
    s_barrier
    v_mfma_f32_32x32x16_bf16 v[96:111], a[168:171], a[124:127], v[96:111]
    ds_read_b64_tr_b16 a[152:153], v32 offset:0
    ds_read_b64_tr_b16 a[154:155], v32 offset:256
    ds_read_b64_tr_b16 a[156:157], v32 offset:8192
    ds_read_b64 v[240:241], v60 offset:0
    ds_read_b64 v[244:245], v60 offset:520
    ds_read_b64 v[248:249], v60 offset:1040
    v_cvt_pk_bf16_f32 v232, v42, v42
    v_and_b32 v232, 0xffff0000, v232
    v_sub_f32 v233, v42, v232
    v_cvt_pk_bf16_f32 v16, v232, v233
    v_mfma_f32_32x32x16_bf16 v[112:127], a[168:171], a[144:147], v[112:127]
    ds_read_b64_tr_b16 a[158:159], v32 offset:8448
    ds_read_b64_tr_b16 a[160:161], v32 offset:16384
    ds_read_b64_tr_b16 a[162:163], v32 offset:16640
    s_bfe_u32 s85, s84, 196624
    s_add_u32 m0, s72, 49152
    s_mul_i32 s69, s85, 196608
    buffer_load_dwordx4 v28, s[28:31], s69 offen  lds
    v_mov_b32 v17, v16
    v_mov_b32 v18, v16
    v_mov_b32 v19, v16
    v_mfma_f32_32x32x16_bf16 v[128:143], a[172:175], a[124:127], v[128:143]
    v_mfma_f32_32x32x16_bf16 v[144:159], a[172:175], a[144:147], v[144:159]
    ds_read_b64_tr_b16 a[164:165], v34 offset:0
    ds_read_b64_tr_b16 a[166:167], v34 offset:256
    ds_read_b64_tr_b16 a[168:169], v34 offset:8192
    ds_read_b64_tr_b16 a[170:171], v34 offset:8448
    ds_read_b64_tr_b16 a[172:173], v34 offset:16384
    ds_read_b64_tr_b16 a[174:175], v34 offset:16640
    s_waitcnt lgkmcnt(11)
    v_mfma_f32_32x32x16_bf16 v[64:79], v[240:243], v[12:15], v[64:79]
    ds_read_b64_tr_b16 a[176:177], v36 offset:0
    ds_read_b64_tr_b16 a[178:179], v36 offset:256
    v_mfma_f32_32x32x16_bf16 v[80:95], v[240:243], v[16:19], v[80:95]
    ds_read_b64_tr_b16 a[180:181], v36 offset:8192
    ds_read_b64_tr_b16 a[182:183], v36 offset:8448
    buffer_load_dwordx4 v29, s[28:31], s69 offen offset:1024  lds
    s_add_u32 m0, s72, 57344
    s_waitcnt lgkmcnt(14)
    v_mfma_f32_32x32x16_bf16 v[96:111], v[244:247], v[12:15], v[96:111]
    ds_read_b64_tr_b16 a[184:185], v36 offset:16384
    ds_read_b64_tr_b16 a[186:187], v36 offset:16640
    v_mfma_f32_32x32x16_bf16 v[112:127], v[244:247], v[16:19], v[112:127]
    s_xor_b32 s76, s77, 4096
    s_sub_u32 s75, 90112, s78
    v_mul_f32 v64, v64, v4
    v_mul_f32 v65, v65, v4
    v_mul_f32 v66, v66, v4
    s_waitcnt lgkmcnt(15)
    v_mfma_f32_32x32x16_bf16 v[128:143], v[248:251], v[12:15], v[128:143]
    v_mul_f32 v67, v67, v4
    v_mul_f32 v68, v68, v4
    v_mul_f32 v69, v69, v4
    v_mul_f32 v70, v70, v4
    v_mfma_f32_32x32x16_bf16 v[144:159], v[248:251], v[16:19], v[144:159]
    s_mul_i32 s70, s85, 176128
    buffer_load_dwordx4 v30, s[32:35], s70 offen  lds
    v_mul_f32 v71, v71, v4
    v_cvt_pk_bf16_f32 v64, v64, v65
    v_cvt_pk_bf16_f32 v65, v66, v67
    v_cvt_pk_bf16_f32 v66, v68, v69
    v_cvt_pk_bf16_f32 v67, v70, v71
    s_waitcnt lgkmcnt(6)
    v_mfma_f32_32x32x16_bf16 v[160:175], a[152:155], a[0:3], 0
    ds_read_b64_tr_b16 a[188:189], v38 offset:0
    ds_read_b64_tr_b16 a[190:191], v38 offset:256
    buffer_store_dwordx4 v[64:67], v53, s[52:55], s77 offen sc1
    v_mul_f32 v72, v72, v4
    v_mul_f32 v73, v73, v4
    v_mul_f32 v74, v74, v4
    v_mul_f32 v75, v75, v4
    v_mfma_f32_16x16x32_bf16 v[48:51], a[152:155], a[128:131], 0
    v_mul_f32 v76, v76, v4
    v_mul_f32 v77, v77, v4
    v_mfma_f32_32x32x16_bf16 v[176:191], a[156:159], a[0:3], 0
    ds_read_b64_tr_b16 a[192:193], v38 offset:8192
    ds_read_b64_tr_b16 a[194:195], v38 offset:8448
    v_mul_f32 v78, v78, v4
    v_mul_f32 v79, v79, v4
    v_cvt_pk_bf16_f32 v68, v72, v73
    v_cvt_pk_bf16_f32 v69, v74, v75
    v_mfma_f32_16x16x32_bf16 v[48:51], a[156:159], a[132:135], v[48:51]
    v_cvt_pk_bf16_f32 v70, v76, v77
    v_cvt_pk_bf16_f32 v71, v78, v79
    v_mfma_f32_32x32x16_bf16 v[192:207], a[160:163], a[0:3], 0
    ds_read_b64_tr_b16 a[196:197], v38 offset:16384
    ds_read_b64_tr_b16 a[198:199], v38 offset:16640
    buffer_load_dwordx4 v31, s[32:35], s70 offen offset:1024  lds
    s_add_u32 m0, s72, 65536
    buffer_store_dwordx4 v[68:71], v53, s[52:55], s77 offen offset:1024 sc1
    v_mul_f32 v80, v80, v8
    v_mul_f32 v81, v81, v8
    v_mul_f32 v82, v82, v8
    v_mfma_f32_16x16x32_bf16 v[48:51], a[160:163], a[136:139], v[48:51]
    v_mul_f32 v83, v83, v8
    v_mul_f32 v84, v84, v8
    v_mfma_f32_32x32x16_bf16 v[160:175], a[164:167], a[4:7], v[160:175]
    ds_read_b64_tr_b16 a[152:153], v32 offset:4096
    ds_read_b64_tr_b16 a[154:155], v32 offset:4352
    v_mul_f32 v85, v85, v8
    v_mul_f32 v86, v86, v8
    v_mul_f32 v87, v87, v8
    v_cvt_pk_bf16_f32 v80, v80, v81
    v_cvt_pk_bf16_f32 v81, v82, v83
    v_mfma_f32_32x32x16_bf16 v[176:191], a[168:171], a[4:7], v[176:191]
    ds_read_b64_tr_b16 a[156:157], v32 offset:12288
    ds_read_b64_tr_b16 a[158:159], v32 offset:12544
    v_cvt_pk_bf16_f32 v82, v84, v85
    v_cvt_pk_bf16_f32 v83, v86, v87
    v_mul_f32 v88, v88, v8
    v_mul_f32 v89, v89, v8
    v_mfma_f32_32x32x16_bf16 v[192:207], a[172:175], a[4:7], v[192:207]
    ds_read_b64_tr_b16 a[160:161], v32 offset:20480
    ds_read_b64_tr_b16 a[162:163], v32 offset:20736
    buffer_store_dwordx4 v[80:83], v53, s[52:55], s76 offen sc1
    v_mul_f32 v90, v90, v8
    v_mul_f32 v91, v91, v8
    v_mul_f32 v92, v92, v8
    v_mul_f32 v93, v93, v8
    s_waitcnt lgkmcnt(6)
    v_mfma_f32_32x32x16_bf16 v[160:175], a[176:179], a[8:11], v[160:175]
    ds_read_b64_tr_b16 a[164:165], v34 offset:4096
    ds_read_b64_tr_b16 a[166:167], v34 offset:4352
    buffer_load_dwordx4 v30, s[36:39], s70 offen  lds
    v_mul_f32 v94, v94, v8
    v_mul_f32 v95, v95, v8
    v_cvt_pk_bf16_f32 v84, v88, v89
    v_cvt_pk_bf16_f32 v85, v90, v91
    v_cvt_pk_bf16_f32 v86, v92, v93
    v_mfma_f32_32x32x16_bf16 v[176:191], a[180:183], a[8:11], v[176:191]
    ds_read_b64_tr_b16 a[168:169], v34 offset:12288
    ds_read_b64_tr_b16 a[170:171], v34 offset:12544
    v_cvt_pk_bf16_f32 v87, v94, v95
    v_mul_f32 v20, v96, v96
    v_mul_f32 v21, v97, v97
    v_mul_f32 v22, v98, v98
    v_mfma_f32_32x32x16_bf16 v[192:207], a[184:187], a[8:11], v[192:207]
    ds_read_b64_tr_b16 a[172:173], v34 offset:20480
    ds_read_b64_tr_b16 a[174:175], v34 offset:20736
    buffer_store_dwordx4 v[84:87], v53, s[52:55], s76 offen offset:1024 sc1
    v_mul_f32 v23, v99, v99
    v_fma_f32 v20, v20, v6, v5
    v_fma_f32 v21, v21, v6, v5
    v_fma_f32 v22, v22, v6, v5
    v_fma_f32 v23, v23, v6, v5
    v_mfma_f32_32x32x16_bf16 v[160:175], a[188:191], a[12:15], v[160:175]
    ds_read_b64_tr_b16 a[176:177], v36 offset:4096
    ds_read_b64_tr_b16 a[178:179], v36 offset:4352
    v_mul_f32 v20, v96, v20
    v_mul_f32 v21, v97, v21
    v_mul_f32 v22, v98, v22
    v_mul_f32 v23, v99, v23
    v_mfma_f32_32x32x16_bf16 v[176:191], a[192:195], a[12:15], v[176:191]
    ds_read_b64_tr_b16 a[180:181], v36 offset:12288
    ds_read_b64_tr_b16 a[182:183], v36 offset:12544
    buffer_load_dwordx4 v31, s[36:39], s70 offen offset:1024  lds
    v_exp_f32 v20, v20
    v_mul_f32 v96, v96, v128
    v_exp_f32 v21, v21
    v_mfma_f32_32x32x16_bf16 v[192:207], a[196:199], a[12:15], v[192:207]
    ds_read_b64_tr_b16 a[184:185], v36 offset:20480
    ds_read_b64_tr_b16 a[186:187], v36 offset:20736
    v_mul_f32 v97, v97, v129
    v_exp_f32 v22, v22
    v_mul_f32 v98, v98, v130
    s_waitcnt lgkmcnt(6)
    v_mfma_f32_32x32x16_bf16 v[160:175], a[152:155], a[16:19], v[160:175]
    ds_read_b64_tr_b16 a[188:189], v38 offset:4096
    ds_read_b64_tr_b16 a[190:191], v38 offset:4352
    ds_read_b64_tr_b16 a[192:193], v38 offset:12288
    v_exp_f32 v23, v23
    v_mul_f32 v99, v99, v131
    v_fma_f32 v20, v20, v7, v7
    v_fma_f32 v21, v21, v7, v7
    v_mfma_f32_16x16x32_bf16 v[48:51], a[152:155], a[128:131], v[48:51]
    v_fma_f32 v22, v22, v7, v7
    v_fma_f32 v23, v23, v7, v7
    v_mfma_f32_32x32x16_bf16 v[176:191], a[156:159], a[16:19], v[176:191]
    ds_read_b64_tr_b16 a[194:195], v38 offset:12544
    ds_read_b64_tr_b16 a[196:197], v38 offset:20480
    ds_read_b64_tr_b16 a[198:199], v38 offset:20736
    v_rcp_f32 v20, v20
    v_mfma_f32_16x16x32_bf16 v[48:51], a[156:159], a[132:135], v[48:51]
    v_rcp_f32 v21, v21
    v_rcp_f32 v22, v22
    v_mfma_f32_32x32x16_bf16 v[192:207], a[160:163], a[16:19], v[192:207]
    v_rcp_f32 v23, v23
    v_mul_f32 v96, v96, v20
    v_mul_f32 v97, v97, v21
    v_mul_f32 v98, v98, v22
    v_mfma_f32_16x16x32_bf16 v[48:51], a[160:163], a[136:139], v[48:51]
    v_mul_f32 v99, v99, v23
    v_cvt_pk_bf16_f32 v128, v96, v97
    v_mfma_f32_32x32x16_bf16 v[160:175], a[164:167], a[20:23], v[160:175]
    v_cvt_pk_bf16_f32 v129, v98, v99
    v_mul_f32 v24, v100, v100
    v_mul_f32 v25, v101, v101
    v_mul_f32 v26, v102, v102
    v_mul_f32 v27, v103, v103
    s_waitcnt lgkmcnt(0)
    s_waitcnt vmcnt(10)
    s_barrier
    v_mfma_f32_32x32x16_bf16 v[176:191], a[168:171], a[20:23], v[176:191]
    ds_read_b64_tr_b16 a[152:153], v32 offset:24576
    ds_read_b64_tr_b16 a[154:155], v32 offset:24832
    ds_read_b64_tr_b16 a[156:157], v32 offset:32768
    v_fma_f32 v24, v24, v6, v5
    v_fma_f32 v25, v25, v6, v5
    v_fma_f32 v26, v26, v6, v5
    v_fma_f32 v27, v27, v6, v5
    v_mfma_f32_32x32x16_bf16 v[192:207], a[172:175], a[20:23], v[192:207]
    ds_read_b64_tr_b16 a[158:159], v32 offset:33024
    ds_read_b64_tr_b16 a[160:161], v32 offset:40960
    ds_read_b64_tr_b16 a[162:163], v32 offset:41216
    s_bfe_u32 s85, s84, 196632
    s_add_u32 m0, s72, 73728
    s_mul_i32 s69, s85, 196608
    buffer_load_dwordx4 v28, s[28:31], s69 offen  lds
    v_mul_f32 v24, v100, v24
    v_mul_f32 v25, v101, v25
    v_mul_f32 v26, v102, v26
    v_mul_f32 v27, v103, v27
    v_exp_f32 v24, v24
    v_mfma_f32_32x32x16_bf16 v[160:175], a[176:179], a[24:27], v[160:175]
    ds_read_b64_tr_b16 a[164:165], v34 offset:24576
    ds_read_b64_tr_b16 a[166:167], v34 offset:24832
    v_mul_f32 v100, v100, v132
    v_exp_f32 v25, v25
    v_mul_f32 v101, v101, v133
    v_mfma_f32_32x32x16_bf16 v[176:191], a[180:183], a[24:27], v[176:191]
    ds_read_b64_tr_b16 a[168:169], v34 offset:32768
    ds_read_b64_tr_b16 a[170:171], v34 offset:33024
    buffer_load_dwordx4 v29, s[28:31], s69 offen offset:1024  lds
    s_add_u32 m0, s72, 81920
    v_exp_f32 v26, v26
    v_mul_f32 v102, v102, v134
    v_exp_f32 v27, v27
    v_mfma_f32_32x32x16_bf16 v[192:207], a[184:187], a[24:27], v[192:207]
    ds_read_b64_tr_b16 a[172:173], v34 offset:40960
    ds_read_b64_tr_b16 a[174:175], v34 offset:41216
    v_mul_f32 v103, v103, v135
    v_fma_f32 v24, v24, v7, v7
    v_fma_f32 v25, v25, v7, v7
    v_fma_f32 v26, v26, v7, v7
    v_mfma_f32_32x32x16_bf16 v[160:175], a[188:191], a[28:31], v[160:175]
    ds_read_b64_tr_b16 a[176:177], v36 offset:24576
    ds_read_b64_tr_b16 a[178:179], v36 offset:24832
    s_mul_i32 s70, s85, 176128
    buffer_load_dwordx4 v30, s[32:35], s70 offen  lds
    v_fma_f32 v27, v27, v7, v7
    v_rcp_f32 v24, v24
    v_rcp_f32 v25, v25
    v_mfma_f32_32x32x16_bf16 v[176:191], a[192:195], a[28:31], v[176:191]
    ds_read_b64_tr_b16 a[180:181], v36 offset:32768
    ds_read_b64_tr_b16 a[182:183], v36 offset:33024
    v_rcp_f32 v26, v26
    v_rcp_f32 v27, v27
    v_mul_f32 v100, v100, v24
    v_mfma_f32_32x32x16_bf16 v[192:207], a[196:199], a[28:31], v[192:207]
    ds_read_b64_tr_b16 a[184:185], v36 offset:40960
    ds_read_b64_tr_b16 a[186:187], v36 offset:41216
    buffer_load_dwordx4 v31, s[32:35], s70 offen offset:1024  lds
    s_add_u32 m0, s72, 90112
    v_mul_f32 v101, v101, v25
    v_mul_f32 v102, v102, v26
    v_mul_f32 v103, v103, v27
    v_cvt_pk_bf16_f32 v130, v100, v101
    v_cvt_pk_bf16_f32 v131, v102, v103
    s_waitcnt lgkmcnt(6)
    v_mfma_f32_32x32x16_bf16 v[160:175], a[152:155], a[32:35], v[160:175]
    ds_read_b64_tr_b16 a[188:189], v38 offset:24576
    ds_read_b64_tr_b16 a[190:191], v38 offset:24832
    buffer_store_dwordx4 v[128:131], v54, s[52:55], s78 offen sc1
    v_mul_f32 v20, v104, v104
    v_mul_f32 v21, v105, v105
    v_mul_f32 v22, v106, v106
    v_mfma_f32_16x16x32_bf16 v[48:51], a[152:155], a[128:131], v[48:51]
    v_mul_f32 v23, v107, v107
    v_fma_f32 v20, v20, v6, v5
    v_mfma_f32_32x32x16_bf16 v[176:191], a[156:159], a[32:35], v[176:191]
    ds_read_b64_tr_b16 a[192:193], v38 offset:32768
    ds_read_b64_tr_b16 a[194:195], v38 offset:33024
    buffer_load_dwordx4 v30, s[36:39], s70 offen  lds
    v_fma_f32 v21, v21, v6, v5
    v_fma_f32 v22, v22, v6, v5
    v_fma_f32 v23, v23, v6, v5
    v_mul_f32 v20, v104, v20
    v_mfma_f32_16x16x32_bf16 v[48:51], a[156:159], a[132:135], v[48:51]
    v_mul_f32 v21, v105, v21
    v_mul_f32 v22, v106, v22
    v_mfma_f32_32x32x16_bf16 v[192:207], a[160:163], a[32:35], v[192:207]
    ds_read_b64_tr_b16 a[196:197], v38 offset:40960
    ds_read_b64_tr_b16 a[198:199], v38 offset:41216
    buffer_load_dwordx4 v31, s[36:39], s70 offen offset:1024  lds
    v_mov_b32 v1, 1
    s_mov_b32 s73, 0
    s_waitcnt vmcnt(8)
    buffer_store_dword v1, v55, s[52:55], s73 offen sc1
    v_mul_f32 v23, v107, v23
    v_mfma_f32_16x16x32_bf16 v[48:51], a[160:163], a[136:139], v[48:51]
    v_exp_f32 v20, v20
    v_mul_f32 v104, v104, v136
    v_mfma_f32_32x32x16_bf16 v[160:175], a[164:167], a[36:39], v[160:175]
    ds_read_b64_tr_b16 a[152:153], v32 offset:28672
    ds_read_b64_tr_b16 a[154:155], v32 offset:28928
    v_exp_f32 v21, v21
    v_mul_f32 v105, v105, v137
    v_exp_f32 v22, v22
    v_mfma_f32_32x32x16_bf16 v[176:191], a[168:171], a[36:39], v[176:191]
    ds_read_b64_tr_b16 a[156:157], v32 offset:36864
    ds_read_b64_tr_b16 a[158:159], v32 offset:37120
    v_mul_f32 v106, v106, v138
    v_exp_f32 v23, v23
    v_mul_f32 v107, v107, v139
    v_mfma_f32_32x32x16_bf16 v[192:207], a[172:175], a[36:39], v[192:207]
    ds_read_b64_tr_b16 a[160:161], v32 offset:45056
    ds_read_b64_tr_b16 a[162:163], v32 offset:45312
    s_add_u32 m0, s80, 0
    s_nop 0
    buffer_load_dwordx4 v62, s[40:43], s94 offen  lds
    v_fma_f32 v20, v20, v7, v7
    v_fma_f32 v21, v21, v7, v7
    v_fma_f32 v22, v22, v7, v7
    v_fma_f32 v23, v23, v7, v7
    s_waitcnt lgkmcnt(6)
    v_mfma_f32_32x32x16_bf16 v[160:175], a[176:179], a[40:43], v[160:175]
    ds_read_b64_tr_b16 a[164:165], v34 offset:28672
    ds_read_b64_tr_b16 a[166:167], v34 offset:28928
    v_rcp_f32 v20, v20
    v_rcp_f32 v21, v21
    v_rcp_f32 v22, v22
    v_mfma_f32_32x32x16_bf16 v[176:191], a[180:183], a[40:43], v[176:191]
    ds_read_b64_tr_b16 a[168:169], v34 offset:36864
    ds_read_b64_tr_b16 a[170:171], v34 offset:37120
    buffer_load_dwordx4 v63, s[40:43], s94 offen offset:1024  lds
    v_rcp_f32 v23, v23
    v_mul_f32 v104, v104, v20
    v_mul_f32 v105, v105, v21
    v_mfma_f32_32x32x16_bf16 v[192:207], a[184:187], a[40:43], v[192:207]
    ds_read_b64_tr_b16 a[172:173], v34 offset:45056
    ds_read_b64_tr_b16 a[174:175], v34 offset:45312
    v_mul_f32 v106, v106, v22
    v_mul_f32 v107, v107, v23
    v_cvt_pk_bf16_f32 v132, v104, v105
    v_cvt_pk_bf16_f32 v133, v106, v107
    v_mul_f32 v24, v108, v108
    v_mfma_f32_32x32x16_bf16 v[160:175], a[188:191], a[44:47], v[160:175]
    ds_read_b64_tr_b16 a[176:177], v36 offset:28672
    ds_read_b64_tr_b16 a[178:179], v36 offset:28928
    s_add_u32 m0, s80, 2048
    s_add_u32 s81, s94, 16384
    buffer_load_dwordx4 v62, s[40:43], s81 offen  lds
    v_mul_f32 v25, v109, v109
    v_mul_f32 v26, v110, v110
    v_mul_f32 v27, v111, v111
    v_fma_f32 v24, v24, v6, v5
    v_fma_f32 v25, v25, v6, v5
    v_mfma_f32_32x32x16_bf16 v[176:191], a[192:195], a[44:47], v[176:191]
    ds_read_b64_tr_b16 a[180:181], v36 offset:36864
    ds_read_b64_tr_b16 a[182:183], v36 offset:37120
    v_fma_f32 v26, v26, v6, v5
    v_fma_f32 v27, v27, v6, v5
    v_mul_f32 v24, v108, v24
    v_mul_f32 v25, v109, v25
    v_mul_f32 v26, v110, v26
    v_mfma_f32_32x32x16_bf16 v[192:207], a[196:199], a[44:47], v[192:207]
    ds_read_b64_tr_b16 a[184:185], v36 offset:45056
    ds_read_b64_tr_b16 a[186:187], v36 offset:45312
    buffer_load_dwordx4 v63, s[40:43], s81 offen offset:1024  lds
    v_mul_f32 v27, v111, v27
    v_exp_f32 v24, v24
    v_mul_f32 v108, v108, v140
    s_waitcnt lgkmcnt(6)
    v_mfma_f32_32x32x16_bf16 v[160:175], a[152:155], a[48:51], v[160:175]
    ds_read_b64_tr_b16 a[188:189], v38 offset:28672
    ds_read_b64_tr_b16 a[190:191], v38 offset:28928
    ds_read_b64_tr_b16 a[192:193], v38 offset:36864
    v_exp_f32 v25, v25
    v_mul_f32 v109, v109, v141
    v_mfma_f32_16x16x32_bf16 v[48:51], a[152:155], a[128:131], v[48:51]
    v_exp_f32 v26, v26
    v_mul_f32 v110, v110, v142
    v_mfma_f32_32x32x16_bf16 v[176:191], a[156:159], a[48:51], v[176:191]
    ds_read_b64_tr_b16 a[194:195], v38 offset:37120
    ds_read_b64_tr_b16 a[196:197], v38 offset:45056
    ds_read_b64_tr_b16 a[198:199], v38 offset:45312
    s_add_u32 m0, s80, 4096
    s_nop 0
    buffer_load_dwordx4 v62, s[40:43], s95 offen  lds
    v_exp_f32 v27, v27
    v_mul_f32 v111, v111, v143
    v_fma_f32 v24, v24, v7, v7
    v_fma_f32 v25, v25, v7, v7
    v_mfma_f32_16x16x32_bf16 v[48:51], a[156:159], a[132:135], v[48:51]
    v_fma_f32 v26, v26, v7, v7
    v_fma_f32 v27, v27, v7, v7
    v_mfma_f32_32x32x16_bf16 v[192:207], a[160:163], a[48:51], v[192:207]
    buffer_load_dwordx4 v63, s[40:43], s95 offen offset:1024  lds
    v_rcp_f32 v24, v24
    v_mfma_f32_16x16x32_bf16 v[48:51], a[160:163], a[136:139], v[48:51]
    v_rcp_f32 v25, v25
    v_rcp_f32 v26, v26
    v_mfma_f32_32x32x16_bf16 v[160:175], a[164:167], a[52:55], v[160:175]
    v_rcp_f32 v27, v27
    v_mul_f32 v108, v108, v24
    v_mul_f32 v109, v109, v25
    v_mul_f32 v110, v110, v26
    s_waitcnt lgkmcnt(0)
    s_waitcnt vmcnt(14)
    s_barrier
    v_mfma_f32_32x32x16_bf16 v[176:191], a[168:171], a[52:55], v[176:191]
    ds_read_b64_tr_b16 a[152:153], v33 offset:0
    ds_read_b64_tr_b16 a[154:155], v33 offset:256
    ds_read_b64_tr_b16 a[156:157], v33 offset:8192
    v_mul_f32 v111, v111, v27
    v_cvt_pk_bf16_f32 v134, v108, v109
    v_cvt_pk_bf16_f32 v135, v110, v111
    v_mfma_f32_32x32x16_bf16 v[192:207], a[172:175], a[52:55], v[192:207]
    ds_read_b64_tr_b16 a[158:159], v33 offset:8448
    ds_read_b64_tr_b16 a[160:161], v33 offset:16384
    ds_read_b64_tr_b16 a[162:163], v33 offset:16640
    buffer_store_dwordx4 v[132:135], v54, s[52:55], s78 offen offset:1024 sc1
    ds_write_b128 v52, a[200:203] offset:49152
    ds_write_b128 v52, a[200:203] offset:50176
    v_accvgpr_read_b32 v64, a216
    v_accvgpr_read_b32 v65, a217
    v_accvgpr_read_b32 v66, a218
    v_accvgpr_read_b32 v67, a219
    v_mfma_f32_32x32x16_bf16 v[160:175], a[176:179], a[56:59], v[160:175]
    ds_read_b64_tr_b16 a[164:165], v35 offset:0
    ds_read_b64_tr_b16 a[166:167], v35 offset:256
    s_add_u32 m0, s80, 24576
    s_add_u32 s81, s95, 16384
    buffer_load_dwordx4 v62, s[40:43], s81 offen  lds
    v_accvgpr_read_b32 v68, a220
    v_accvgpr_read_b32 v69, a221
    v_accvgpr_read_b32 v70, a222
    v_accvgpr_read_b32 v71, a223
    v_mfma_f32_32x32x16_bf16 v[176:191], a[180:183], a[56:59], v[176:191]
    ds_read_b64_tr_b16 a[168:169], v35 offset:8192
    ds_read_b64_tr_b16 a[170:171], v35 offset:8448
    v_accvgpr_read_b32 v72, a224
    v_accvgpr_read_b32 v73, a225
    v_accvgpr_read_b32 v74, a226
    v_accvgpr_read_b32 v75, a227
    v_accvgpr_read_b32 v76, a228
    v_mfma_f32_32x32x16_bf16 v[192:207], a[184:187], a[56:59], v[192:207]
    ds_read_b64_tr_b16 a[172:173], v35 offset:16384
    ds_read_b64_tr_b16 a[174:175], v35 offset:16640
    v_accvgpr_read_b32 v77, a229
    v_accvgpr_read_b32 v78, a230
    v_accvgpr_read_b32 v79, a231
    v_accvgpr_read_b32 v80, a232
    v_accvgpr_read_b32 v81, a233
    v_mfma_f32_32x32x16_bf16 v[160:175], a[188:191], a[60:63], v[160:175]
    ds_read_b64_tr_b16 a[176:177], v37 offset:0
    ds_read_b64_tr_b16 a[178:179], v37 offset:256
    v_accvgpr_read_b32 v82, a234
    v_accvgpr_read_b32 v83, a235
    v_accvgpr_read_b32 v84, a236
    v_accvgpr_read_b32 v85, a237
    v_accvgpr_read_b32 v86, a238
    v_mfma_f32_32x32x16_bf16 v[176:191], a[192:195], a[60:63], v[176:191]
    ds_read_b64_tr_b16 a[180:181], v37 offset:8192
    ds_read_b64_tr_b16 a[182:183], v37 offset:8448
    buffer_load_dwordx4 v63, s[40:43], s81 offen offset:1024  lds
    v_accvgpr_read_b32 v87, a239
    v_accvgpr_read_b32 v88, a240
    v_accvgpr_read_b32 v89, a241
    v_accvgpr_read_b32 v90, a242
    v_mfma_f32_32x32x16_bf16 v[192:207], a[196:199], a[60:63], v[192:207]
    ds_read_b64_tr_b16 a[184:185], v37 offset:16384
    ds_read_b64_tr_b16 a[186:187], v37 offset:16640
    v_accvgpr_read_b32 v91, a243
    v_accvgpr_read_b32 v92, a244
    v_accvgpr_read_b32 v93, a245
    v_accvgpr_read_b32 v94, a246
    v_accvgpr_read_b32 v95, a247
    s_waitcnt lgkmcnt(6)
    v_mfma_f32_32x32x16_bf16 v[160:175], a[152:155], a[64:67], v[160:175]
    ds_read_b64_tr_b16 a[188:189], v39 offset:0
    ds_read_b64_tr_b16 a[190:191], v39 offset:256
    v_mul_f32 v20, v112, v112
    v_mul_f32 v21, v113, v113
    v_mul_f32 v22, v114, v114
    v_mul_f32 v23, v115, v115
    v_mfma_f32_16x16x32_bf16 v[48:51], a[152:155], a[128:131], v[48:51]
    v_fma_f32 v20, v20, v10, v9
    v_fma_f32 v21, v21, v10, v9
    v_mfma_f32_32x32x16_bf16 v[176:191], a[156:159], a[64:67], v[176:191]
    ds_read_b64_tr_b16 a[192:193], v39 offset:8192
    ds_read_b64_tr_b16 a[194:195], v39 offset:8448
    v_fma_f32 v22, v22, v10, v9
    v_fma_f32 v23, v23, v10, v9
    v_mul_f32 v20, v112, v20
    v_mul_f32 v21, v113, v21
    v_mfma_f32_16x16x32_bf16 v[48:51], a[156:159], a[132:135], v[48:51]
    v_mul_f32 v22, v114, v22
    v_mul_f32 v23, v115, v23
    v_mfma_f32_32x32x16_bf16 v[192:207], a[160:163], a[64:67], v[192:207]
    ds_read_b64_tr_b16 a[196:197], v39 offset:16384
    ds_read_b64_tr_b16 a[198:199], v39 offset:16640
    s_add_u32 m0, s80, 26624
    s_nop 0
    buffer_load_dwordx4 v62, s[40:43], s96 offen  lds
    v_exp_f32 v20, v20
    v_mul_f32 v112, v112, v144
    v_exp_f32 v21, v21
    v_mfma_f32_16x16x32_bf16 v[48:51], a[160:163], a[136:139], v[48:51]
    v_mul_f32 v113, v113, v145
    v_exp_f32 v22, v22
    v_mfma_f32_32x32x16_bf16 v[160:175], a[164:167], a[68:71], v[160:175]
    ds_read_b64_tr_b16 a[152:153], v33 offset:4096
    ds_read_b64_tr_b16 a[154:155], v33 offset:4352
    v_mul_f32 v114, v114, v146
    v_exp_f32 v23, v23
    v_mul_f32 v115, v115, v147
    v_mfma_f32_32x32x16_bf16 v[176:191], a[168:171], a[68:71], v[176:191]
    ds_read_b64_tr_b16 a[156:157], v33 offset:12288
    ds_read_b64_tr_b16 a[158:159], v33 offset:12544
    v_fma_f32 v20, v20, v11, v11
    v_fma_f32 v21, v21, v11, v11
    v_fma_f32 v22, v22, v11, v11
    v_fma_f32 v23, v23, v11, v11
    v_mfma_f32_32x32x16_bf16 v[192:207], a[172:175], a[68:71], v[192:207]
    ds_read_b64_tr_b16 a[160:161], v33 offset:20480
    ds_read_b64_tr_b16 a[162:163], v33 offset:20736
    v_rcp_f32 v20, v20
    v_rcp_f32 v21, v21
    v_rcp_f32 v22, v22
    s_waitcnt lgkmcnt(6)
    v_mfma_f32_32x32x16_bf16 v[160:175], a[176:179], a[72:75], v[160:175]
    ds_read_b64_tr_b16 a[164:165], v35 offset:4096
    ds_read_b64_tr_b16 a[166:167], v35 offset:4352
    buffer_load_dwordx4 v63, s[40:43], s96 offen offset:1024  lds
    v_rcp_f32 v23, v23
    v_mul_f32 v112, v112, v20
    v_mul_f32 v113, v113, v21
    v_mfma_f32_32x32x16_bf16 v[176:191], a[180:183], a[72:75], v[176:191]
    ds_read_b64_tr_b16 a[168:169], v35 offset:12288
    ds_read_b64_tr_b16 a[170:171], v35 offset:12544
    v_mul_f32 v114, v114, v22
    v_mul_f32 v115, v115, v23
    v_cvt_pk_bf16_f32 v144, v112, v113
    v_cvt_pk_bf16_f32 v145, v114, v115
    v_mul_f32 v24, v116, v116
    v_mfma_f32_32x32x16_bf16 v[192:207], a[184:187], a[72:75], v[192:207]
    ds_read_b64_tr_b16 a[172:173], v35 offset:20480
    ds_read_b64_tr_b16 a[174:175], v35 offset:20736
    v_mul_f32 v25, v117, v117
    v_mul_f32 v26, v118, v118
    v_mul_f32 v27, v119, v119
    v_fma_f32 v24, v24, v10, v9
    v_fma_f32 v25, v25, v10, v9
    v_mfma_f32_32x32x16_bf16 v[160:175], a[188:191], a[76:79], v[160:175]
    ds_read_b64_tr_b16 a[176:177], v37 offset:4096
    ds_read_b64_tr_b16 a[178:179], v37 offset:4352
    v_fma_f32 v26, v26, v10, v9
    v_fma_f32 v27, v27, v10, v9
    v_mul_f32 v24, v116, v24
    v_mul_f32 v25, v117, v25
    v_mfma_f32_32x32x16_bf16 v[176:191], a[192:195], a[76:79], v[176:191]
    ds_read_b64_tr_b16 a[180:181], v37 offset:12288
    ds_read_b64_tr_b16 a[182:183], v37 offset:12544
    s_add_u32 m0, s80, 28672
    s_add_u32 s81, s96, 16384
    buffer_load_dwordx4 v62, s[40:43], s81 offen  lds
    v_mul_f32 v26, v118, v26
    v_mul_f32 v27, v119, v27
    v_exp_f32 v24, v24
    v_mul_f32 v116, v116, v148
    v_mfma_f32_32x32x16_bf16 v[192:207], a[196:199], a[76:79], v[192:207]
    ds_read_b64_tr_b16 a[184:185], v37 offset:20480
    ds_read_b64_tr_b16 a[186:187], v37 offset:20736
    v_exp_f32 v25, v25
    v_mul_f32 v117, v117, v149
    v_exp_f32 v26, v26
    s_waitcnt lgkmcnt(6)
    v_mfma_f32_32x32x16_bf16 v[160:175], a[152:155], a[80:83], v[160:175]
    ds_read_b64_tr_b16 a[188:189], v39 offset:4096
    ds_read_b64_tr_b16 a[190:191], v39 offset:4352
    ds_read_b64_tr_b16 a[192:193], v39 offset:12288
    v_mul_f32 v118, v118, v150
    v_exp_f32 v27, v27
    v_mul_f32 v119, v119, v151
    v_mfma_f32_16x16x32_bf16 v[48:51], a[152:155], a[128:131], v[48:51]
    v_fma_f32 v24, v24, v11, v11
    v_fma_f32 v25, v25, v11, v11
    v_mfma_f32_32x32x16_bf16 v[176:191], a[156:159], a[80:83], v[176:191]
    ds_read_b64_tr_b16 a[194:195], v39 offset:12544
    ds_read_b64_tr_b16 a[196:197], v39 offset:20480
    ds_read_b64_tr_b16 a[198:199], v39 offset:20736
    v_fma_f32 v26, v26, v11, v11
    v_fma_f32 v27, v27, v11, v11
    v_mfma_f32_16x16x32_bf16 v[48:51], a[156:159], a[132:135], v[48:51]
    v_rcp_f32 v24, v24
    v_rcp_f32 v25, v25
    v_mfma_f32_32x32x16_bf16 v[192:207], a[160:163], a[80:83], v[192:207]
    buffer_load_dwordx4 v63, s[40:43], s81 offen offset:1024  lds
    v_rcp_f32 v26, v26
    v_rcp_f32 v27, v27
    v_mul_f32 v116, v116, v24
    v_mfma_f32_16x16x32_bf16 v[48:51], a[160:163], a[136:139], v[48:51]
    v_mul_f32 v117, v117, v25
    v_mul_f32 v118, v118, v26
    v_mfma_f32_32x32x16_bf16 v[160:175], a[164:167], a[84:87], v[160:175]
    v_mul_f32 v119, v119, v27
    v_cvt_pk_bf16_f32 v146, v116, v117
    v_cvt_pk_bf16_f32 v147, v118, v119
    buffer_store_dwordx4 v[144:147], v54, s[52:55], s75 offen sc1
    v_mul_f32 v20, v120, v120
    s_waitcnt lgkmcnt(0)
    s_waitcnt vmcnt(15)
    s_barrier
    v_mfma_f32_32x32x16_bf16 v[176:191], a[168:171], a[84:87], v[176:191]
    ds_read_b64_tr_b16 a[152:153], v33 offset:24576
    ds_read_b64_tr_b16 a[154:155], v33 offset:24832
    ds_read_b64_tr_b16 a[156:157], v33 offset:32768
    buffer_load_dword v58, v213, s[52:55], 0 offen sc1
    v_mul_f32 v21, v121, v121
    v_mul_f32 v22, v122, v122
    v_mul_f32 v23, v123, v123
    v_mfma_f32_32x32x16_bf16 v[192:207], a[172:175], a[84:87], v[192:207]
    ds_read_b64_tr_b16 a[158:159], v33 offset:33024
    ds_read_b64_tr_b16 a[160:161], v33 offset:40960
    ds_read_b64_tr_b16 a[162:163], v33 offset:41216
    s_add_u32 m0, s80, 49152
    s_nop 0
    buffer_load_dwordx4 v62, s[40:43], s97 offen  lds
    v_fma_f32 v20, v20, v10, v9
    v_fma_f32 v21, v21, v10, v9
    v_fma_f32 v22, v22, v10, v9
    v_fma_f32 v23, v23, v10, v9
    v_mul_f32 v20, v120, v20
    v_mfma_f32_32x32x16_bf16 v[160:175], a[176:179], a[88:91], v[160:175]
    ds_read_b64_tr_b16 a[164:165], v35 offset:24576
    ds_read_b64_tr_b16 a[166:167], v35 offset:24832
    v_mul_f32 v21, v121, v21
    v_mul_f32 v22, v122, v22
    v_mul_f32 v23, v123, v23
    v_exp_f32 v20, v20
    v_mfma_f32_32x32x16_bf16 v[176:191], a[180:183], a[88:91], v[176:191]
    ds_read_b64_tr_b16 a[168:169], v35 offset:32768
    ds_read_b64_tr_b16 a[170:171], v35 offset:33024
    buffer_load_dwordx4 v63, s[40:43], s97 offen offset:1024  lds
    v_mul_f32 v120, v120, v152
    v_exp_f32 v21, v21
    v_mul_f32 v121, v121, v153
    v_mfma_f32_32x32x16_bf16 v[192:207], a[184:187], a[88:91], v[192:207]
    ds_read_b64_tr_b16 a[172:173], v35 offset:40960
    ds_read_b64_tr_b16 a[174:175], v35 offset:41216
    v_exp_f32 v22, v22
    v_mul_f32 v122, v122, v154
    v_exp_f32 v23, v23
    v_mfma_f32_32x32x16_bf16 v[160:175], a[188:191], a[92:95], v[160:175]
    ds_read_b64_tr_b16 a[176:177], v37 offset:24576
    ds_read_b64_tr_b16 a[178:179], v37 offset:24832
    v_mul_f32 v123, v123, v155
    v_fma_f32 v20, v20, v11, v11
    v_fma_f32 v21, v21, v11, v11
    v_fma_f32 v22, v22, v11, v11
    v_fma_f32 v23, v23, v11, v11
    v_mfma_f32_32x32x16_bf16 v[176:191], a[192:195], a[92:95], v[176:191]
    ds_read_b64_tr_b16 a[180:181], v37 offset:32768
    ds_read_b64_tr_b16 a[182:183], v37 offset:33024
    s_add_u32 m0, s80, 51200
    s_add_u32 s81, s97, 16384
    buffer_load_dwordx4 v62, s[40:43], s81 offen  lds
    v_rcp_f32 v20, v20
    v_rcp_f32 v21, v21
    v_mfma_f32_32x32x16_bf16 v[192:207], a[196:199], a[92:95], v[192:207]
    ds_read_b64_tr_b16 a[184:185], v37 offset:40960
    ds_read_b64_tr_b16 a[186:187], v37 offset:41216
    v_rcp_f32 v22, v22
    v_rcp_f32 v23, v23
    v_mul_f32 v120, v120, v20
    v_mul_f32 v121, v121, v21
    s_waitcnt lgkmcnt(6)
    v_mfma_f32_32x32x16_bf16 v[160:175], a[152:155], a[96:99], v[160:175]
    ds_read_b64_tr_b16 a[188:189], v39 offset:24576
    ds_read_b64_tr_b16 a[190:191], v39 offset:24832
    buffer_load_dwordx4 v63, s[40:43], s81 offen offset:1024  lds
    v_mul_f32 v122, v122, v22
    v_mul_f32 v123, v123, v23
    v_cvt_pk_bf16_f32 v148, v120, v121
    v_cvt_pk_bf16_f32 v149, v122, v123
    v_mfma_f32_16x16x32_bf16 v[48:51], a[152:155], a[128:131], v[48:51]
    v_mul_f32 v24, v124, v124
    v_mul_f32 v25, v125, v125
    v_mfma_f32_32x32x16_bf16 v[176:191], a[156:159], a[96:99], v[176:191]
    ds_read_b64_tr_b16 a[192:193], v39 offset:32768
    ds_read_b64_tr_b16 a[194:195], v39 offset:33024
    v_mul_f32 v26, v126, v126
    v_mul_f32 v27, v127, v127
    v_fma_f32 v24, v24, v10, v9
    v_fma_f32 v25, v25, v10, v9
    v_mfma_f32_16x16x32_bf16 v[48:51], a[156:159], a[132:135], v[48:51]
    v_fma_f32 v26, v26, v10, v9
    v_fma_f32 v27, v27, v10, v9
    v_mfma_f32_32x32x16_bf16 v[192:207], a[160:163], a[96:99], v[192:207]
    ds_read_b64_tr_b16 a[196:197], v39 offset:40960
    ds_read_b64_tr_b16 a[198:199], v39 offset:41216
    s_add_u32 m0, s80, 53248
    s_nop 0
    buffer_load_dwordx4 v62, s[40:43], s98 offen  lds
    v_mul_f32 v24, v124, v24
    v_mul_f32 v25, v125, v25
    v_mul_f32 v26, v126, v26
    v_mul_f32 v27, v127, v27
    v_mfma_f32_16x16x32_bf16 v[48:51], a[160:163], a[136:139], v[48:51]
    v_exp_f32 v24, v24
    v_mul_f32 v124, v124, v156
    v_mfma_f32_32x32x16_bf16 v[160:175], a[164:167], a[100:103], v[160:175]
    ds_read_b64_tr_b16 a[152:153], v33 offset:28672
    ds_read_b64_tr_b16 a[154:155], v33 offset:28928
    v_exp_f32 v25, v25
    v_mul_f32 v125, v125, v157
    v_exp_f32 v26, v26
    v_mfma_f32_32x32x16_bf16 v[176:191], a[168:171], a[100:103], v[176:191]
    ds_read_b64_tr_b16 a[156:157], v33 offset:36864
    ds_read_b64_tr_b16 a[158:159], v33 offset:37120
    buffer_load_dwordx4 v63, s[40:43], s98 offen offset:1024  lds
    v_mul_f32 v126, v126, v158
    v_exp_f32 v27, v27
    v_mul_f32 v127, v127, v159
    v_mfma_f32_32x32x16_bf16 v[192:207], a[172:175], a[100:103], v[192:207]
    ds_read_b64_tr_b16 a[160:161], v33 offset:45056
    ds_read_b64_tr_b16 a[162:163], v33 offset:45312
    v_fma_f32 v24, v24, v11, v11
    v_fma_f32 v25, v25, v11, v11
    v_fma_f32 v26, v26, v11, v11
    v_fma_f32 v27, v27, v11, v11
    s_waitcnt lgkmcnt(6)
    v_mfma_f32_32x32x16_bf16 v[160:175], a[176:179], a[104:107], v[160:175]
    ds_read_b64_tr_b16 a[164:165], v35 offset:28672
    ds_read_b64_tr_b16 a[166:167], v35 offset:28928
    s_waitcnt vmcnt(6)
    v_cmp_eq_u32 vcc, 0, v58
    s_nop 0
    s_cbranch_vccnz L_spin_kv
L_ok_kv:
    v_rcp_f32 v24, v24
    v_rcp_f32 v25, v25
    v_rcp_f32 v26, v26
    v_mfma_f32_32x32x16_bf16 v[176:191], a[180:183], a[104:107], v[176:191]
    ds_read_b64_tr_b16 a[168:169], v35 offset:36864
    ds_read_b64_tr_b16 a[170:171], v35 offset:37120
    s_add_u32 m0, s71, 32768
    s_nop 0
    buffer_load_dwordx4 v212, s[52:55], s8 offen sc1 lds
    v_rcp_f32 v27, v27
    v_mul_f32 v124, v124, v24
    v_mul_f32 v125, v125, v25
    v_mfma_f32_32x32x16_bf16 v[192:207], a[184:187], a[104:107], v[192:207]
    ds_read_b64_tr_b16 a[172:173], v35 offset:45056
    ds_read_b64_tr_b16 a[174:175], v35 offset:45312
    v_mul_f32 v126, v126, v26
    v_mul_f32 v127, v127, v27
    v_cvt_pk_bf16_f32 v150, v124, v125
    v_cvt_pk_bf16_f32 v151, v126, v127
    v_mfma_f32_32x32x16_bf16 v[160:175], a[188:191], a[108:111], v[160:175]
    ds_read_b64_tr_b16 a[176:177], v37 offset:28672
    ds_read_b64_tr_b16 a[178:179], v37 offset:28928
    buffer_store_dwordx4 v[148:151], v54, s[52:55], s75 offen offset:1024 sc1
    buffer_load_dwordx4 v212, s[52:55], s8 offen offset:1024 sc1 lds
    v_mfma_f32_32x32x16_bf16 v[176:191], a[192:195], a[108:111], v[176:191]
    ds_read_b64_tr_b16 a[180:181], v37 offset:36864
    ds_read_b64_tr_b16 a[182:183], v37 offset:37120
    buffer_load_dwordx4 v212, s[52:55], s8 offen offset:2048 sc1 lds
    v_mfma_f32_32x32x16_bf16 v[192:207], a[196:199], a[108:111], v[192:207]
    ds_read_b64_tr_b16 a[184:185], v37 offset:45056
    ds_read_b64_tr_b16 a[186:187], v37 offset:45312
    s_waitcnt lgkmcnt(6)
    v_mfma_f32_32x32x16_bf16 v[160:175], a[152:155], a[112:115], v[160:175]
    ds_read_b64_tr_b16 a[188:189], v39 offset:28672
    ds_read_b64_tr_b16 a[190:191], v39 offset:28928
    v_mfma_f32_16x16x32_bf16 v[48:51], a[152:155], a[128:131], v[48:51]
    ds_read_b64_tr_b16 a[192:193], v39 offset:36864
    buffer_load_dwordx4 v212, s[52:55], s8 offen offset:3072 sc1 lds
    v_mfma_f32_32x32x16_bf16 v[176:191], a[156:159], a[112:115], v[176:191]
    ds_read_b64_tr_b16 a[194:195], v39 offset:37120
    ds_read_b64_tr_b16 a[196:197], v39 offset:45056
    ds_read_b64_tr_b16 a[198:199], v39 offset:45312
    s_add_u32 m0, s71, 16384
    s_nop 0
    buffer_load_dwordx4 v212, s[52:55], s9 offen sc1 lds
    v_mfma_f32_16x16x32_bf16 v[48:51], a[156:159], a[132:135], v[48:51]
    v_mfma_f32_32x32x16_bf16 v[192:207], a[160:163], a[112:115], v[192:207]
    v_mfma_f32_16x16x32_bf16 v[48:51], a[160:163], a[136:139], v[48:51]
    buffer_load_dwordx4 v212, s[52:55], s9 offen offset:1024 sc1 lds
    v_mfma_f32_32x32x16_bf16 v[160:175], a[164:167], a[116:119], v[160:175]
    buffer_load_dwordx4 v212, s[52:55], s9 offen offset:2048 sc1 lds
    s_nop 4
    v_cvt_pk_bf16_f32 v236, v48, v48
    v_and_b32 v237, 0xffff0000, v236
    v_sub_f32 v237, v48, v237
    v_cvt_pk_bf16_f32 v237, v237, v237
    v_cvt_pk_bf16_f32 v252, v49, v49
    v_and_b32 v253, 0xffff0000, v252
    v_mfma_f32_32x32x16_bf16 v[176:191], a[168:171], a[116:119], v[176:191]
    ds_write_b64 v57, v[236:237] offset:53248
    v_sub_f32 v253, v49, v253
    v_cvt_pk_bf16_f32 v253, v253, v253
    v_cvt_pk_bf16_f32 v236, v50, v50
    v_and_b32 v237, 0xffff0000, v236
    v_sub_f32 v237, v50, v237
    v_mfma_f32_32x32x16_bf16 v[192:207], a[172:175], a[116:119], v[192:207]
    ds_write_b64 v57, v[252:253] offset:53264
    buffer_load_dwordx4 v212, s[52:55], s9 offen offset:3072 sc1 lds
    v_cvt_pk_bf16_f32 v237, v237, v237
    v_cvt_pk_bf16_f32 v252, v51, v51
    v_and_b32 v253, 0xffff0000, v252
    v_sub_f32 v253, v51, v253
    v_cvt_pk_bf16_f32 v253, v253, v253
    s_waitcnt lgkmcnt(2)
    v_mfma_f32_32x32x16_bf16 v[160:175], a[176:179], a[120:123], v[160:175]
    ds_write_b64 v57, v[236:237] offset:53280
    ds_write_b64 v57, v[252:253] offset:53296
    s_add_u32 m0, s71, 0
    s_nop 0
    buffer_load_dwordx4 v212, s[52:55], s10 offen sc1 lds
    s_waitcnt lgkmcnt(0)
    s_barrier
    v_mfma_f32_32x32x16_bf16 v[176:191], a[180:183], a[120:123], v[176:191]
    ds_read_b128 v[240:243], v52 offset:53248
    ds_read_b128 v[244:247], v52 offset:54288
    ds_read_b128 v[248:251], v52 offset:55328
    v_mfma_f32_32x32x16_bf16 v[192:207], a[184:187], a[120:123], v[192:207]
    buffer_load_dwordx4 v212, s[52:55], s10 offen offset:1024 sc1 lds
    v_mfma_f32_32x32x16_bf16 v[160:175], a[188:191], a[124:127], v[160:175]
    buffer_load_dwordx4 v212, s[52:55], s10 offen offset:2048 sc1 lds
    v_mfma_f32_32x32x16_bf16 v[176:191], a[192:195], a[124:127], v[176:191]
    v_mfma_f32_32x32x16_bf16 v[192:207], a[196:199], a[124:127], v[192:207]
    buffer_load_dwordx4 v212, s[52:55], s10 offen offset:3072 sc1 lds
    s_waitcnt lgkmcnt(2)
    v_mfma_f32_32x32x16_bf16 v[160:175], v[240:243], v[12:15], v[160:175]
    s_add_u32 m0, s80, 73728
    s_add_u32 s81, s98, 16384
    buffer_load_dwordx4 v62, s[40:43], s81 offen  lds
    buffer_load_dwordx4 v63, s[40:43], s81 offen offset:1024  lds
    s_waitcnt lgkmcnt(1)
    v_mfma_f32_32x32x16_bf16 v[176:191], v[244:247], v[12:15], v[176:191]
    s_add_u32 m0, s80, 75776
    s_nop 0
    buffer_load_dwordx4 v62, s[40:43], s99 offen  lds
    buffer_load_dwordx4 v63, s[40:43], s99 offen offset:1024  lds
    s_waitcnt lgkmcnt(0)
    v_mfma_f32_32x32x16_bf16 v[192:207], v[248:251], v[12:15], v[192:207]
    s_add_u32 m0, s80, 77824
    s_add_u32 s81, s99, 16384
    buffer_load_dwordx4 v62, s[40:43], s81 offen  lds
    buffer_load_dwordx4 v63, s[40:43], s81 offen offset:1024  lds
    v_mul_f32 v160, v160, v229
    v_mul_f32 v161, v161, v229
    v_mul_f32 v162, v162, v229
    v_mul_f32 v163, v163, v229
    v_mul_f32 v164, v164, v229
    v_mul_f32 v165, v165, v229
    v_mul_f32 v166, v166, v229
    v_mul_f32 v167, v167, v229
    v_mul_f32 v168, v168, v229
    v_mul_f32 v169, v169, v229
    v_mul_f32 v170, v170, v229
    v_mul_f32 v171, v171, v229
    v_mul_f32 v172, v172, v229
    v_mul_f32 v173, v173, v229
    v_mul_f32 v174, v174, v229
    v_mul_f32 v175, v175, v229
    v_cvt_pk_bf16_f32 v144, v160, v161
    v_cvt_pk_bf16_f32 v145, v162, v163
    v_cvt_pk_bf16_f32 v146, v164, v165
    v_cvt_pk_bf16_f32 v147, v166, v167
    v_cvt_pk_bf16_f32 v148, v168, v169
    v_cvt_pk_bf16_f32 v149, v170, v171
    v_cvt_pk_bf16_f32 v150, v172, v173
    v_cvt_pk_bf16_f32 v151, v174, v175
    v_pk_mul_f32 v[20:21], v[176:177], v[176:177]
    v_pk_mul_f32 v[22:23], v[178:179], v[178:179]
    v_pk_mul_f32 v[24:25], v[180:181], v[180:181]
    v_pk_mul_f32 v[26:27], v[182:183], v[182:183]
    v_pk_fma_f32 v[20:21], v[20:21], v[6:7], v[4:5] op_sel:[0,0,1] op_sel_hi:[1,0,1]
    v_pk_fma_f32 v[22:23], v[22:23], v[6:7], v[4:5] op_sel:[0,0,1] op_sel_hi:[1,0,1]
    v_pk_fma_f32 v[24:25], v[24:25], v[6:7], v[4:5] op_sel:[0,0,1] op_sel_hi:[1,0,1]
    v_pk_fma_f32 v[26:27], v[26:27], v[6:7], v[4:5] op_sel:[0,0,1] op_sel_hi:[1,0,1]
    v_pk_mul_f32 v[20:21], v[176:177], v[20:21]
    v_pk_mul_f32 v[22:23], v[178:179], v[22:23]
    v_pk_mul_f32 v[24:25], v[180:181], v[24:25]
    v_pk_mul_f32 v[26:27], v[182:183], v[26:27]
    v_exp_f32 v20, v20
    v_exp_f32 v21, v21
    v_pk_mul_f32 v[176:177], v[176:177], v[192:193]
    v_exp_f32 v22, v22
    v_exp_f32 v23, v23
    v_pk_mul_f32 v[178:179], v[178:179], v[194:195]
    v_exp_f32 v24, v24
    v_exp_f32 v25, v25
    v_pk_mul_f32 v[180:181], v[180:181], v[196:197]
    v_exp_f32 v26, v26
    v_exp_f32 v27, v27
    v_pk_mul_f32 v[182:183], v[182:183], v[198:199]
    v_pk_fma_f32 v[20:21], v[20:21], v[6:7], v[6:7] op_sel:[0,1,1] op_sel_hi:[1,1,1]
    v_pk_fma_f32 v[22:23], v[22:23], v[6:7], v[6:7] op_sel:[0,1,1] op_sel_hi:[1,1,1]
    v_pk_fma_f32 v[24:25], v[24:25], v[6:7], v[6:7] op_sel:[0,1,1] op_sel_hi:[1,1,1]
    v_pk_fma_f32 v[26:27], v[26:27], v[6:7], v[6:7] op_sel:[0,1,1] op_sel_hi:[1,1,1]
    v_rcp_f32 v20, v20
    v_rcp_f32 v21, v21
    v_rcp_f32 v22, v22
    v_rcp_f32 v23, v23
    v_rcp_f32 v24, v24
    v_rcp_f32 v25, v25
    v_rcp_f32 v26, v26
    v_rcp_f32 v27, v27
    v_pk_mul_f32 v[176:177], v[176:177], v[20:21]
    v_pk_mul_f32 v[178:179], v[178:179], v[22:23]
    v_pk_mul_f32 v[180:181], v[180:181], v[24:25]
    v_pk_mul_f32 v[182:183], v[182:183], v[26:27]
    v_cvt_pk_bf16_f32 v192, v176, v177
    v_cvt_pk_bf16_f32 v193, v178, v179
    v_cvt_pk_bf16_f32 v194, v180, v181
    v_cvt_pk_bf16_f32 v195, v182, v183
    buffer_store_dwordx4 v[192:195], v54, s[52:55], s66 offen sc1
    buffer_load_dwordx4 v[28:31], v217, s[24:27], 0 offen
    buffer_load_dwordx4 v[32:35], v218, s[24:27], 0 offen
    v_pk_mul_f32 v[20:21], v[184:185], v[184:185]
    v_pk_mul_f32 v[22:23], v[186:187], v[186:187]
    v_pk_mul_f32 v[24:25], v[188:189], v[188:189]
    v_pk_mul_f32 v[26:27], v[190:191], v[190:191]
    v_pk_fma_f32 v[20:21], v[20:21], v[6:7], v[4:5] op_sel:[0,0,1] op_sel_hi:[1,0,1]
    v_pk_fma_f32 v[22:23], v[22:23], v[6:7], v[4:5] op_sel:[0,0,1] op_sel_hi:[1,0,1]
    v_pk_fma_f32 v[24:25], v[24:25], v[6:7], v[4:5] op_sel:[0,0,1] op_sel_hi:[1,0,1]
    v_pk_fma_f32 v[26:27], v[26:27], v[6:7], v[4:5] op_sel:[0,0,1] op_sel_hi:[1,0,1]
    v_pk_mul_f32 v[20:21], v[184:185], v[20:21]
    v_pk_mul_f32 v[22:23], v[186:187], v[22:23]
    v_pk_mul_f32 v[24:25], v[188:189], v[24:25]
    v_pk_mul_f32 v[26:27], v[190:191], v[26:27]
    v_exp_f32 v20, v20
    v_mov_b32 v1, 1
    s_mov_b32 s73, 8192
    s_waitcnt vmcnt(20)
    buffer_store_dword v1, v55, s[52:55], s73 offen sc1
    v_exp_f32 v21, v21
    v_pk_mul_f32 v[184:185], v[184:185], v[200:201]
    v_exp_f32 v22, v22
    v_exp_f32 v23, v23
    v_pk_mul_f32 v[186:187], v[186:187], v[202:203]
    v_exp_f32 v24, v24
    v_exp_f32 v25, v25
    v_pk_mul_f32 v[188:189], v[188:189], v[204:205]
    v_exp_f32 v26, v26
    v_exp_f32 v27, v27
    v_pk_mul_f32 v[190:191], v[190:191], v[206:207]
    v_pk_fma_f32 v[20:21], v[20:21], v[6:7], v[6:7] op_sel:[0,1,1] op_sel_hi:[1,1,1]
    v_pk_fma_f32 v[22:23], v[22:23], v[6:7], v[6:7] op_sel:[0,1,1] op_sel_hi:[1,1,1]
    v_pk_fma_f32 v[24:25], v[24:25], v[6:7], v[6:7] op_sel:[0,1,1] op_sel_hi:[1,1,1]
    v_pk_fma_f32 v[26:27], v[26:27], v[6:7], v[6:7] op_sel:[0,1,1] op_sel_hi:[1,1,1]
    v_rcp_f32 v20, v20
    v_rcp_f32 v21, v21
    v_rcp_f32 v22, v22
    v_rcp_f32 v23, v23
    v_rcp_f32 v24, v24
    v_rcp_f32 v25, v25
    v_rcp_f32 v26, v26
    v_rcp_f32 v27, v27
    v_pk_mul_f32 v[184:185], v[184:185], v[20:21]
    v_pk_mul_f32 v[186:187], v[186:187], v[22:23]
    v_pk_mul_f32 v[188:189], v[188:189], v[24:25]
    v_pk_mul_f32 v[190:191], v[190:191], v[26:27]
    v_cvt_pk_bf16_f32 v196, v184, v185
    v_cvt_pk_bf16_f32 v197, v186, v187
    v_cvt_pk_bf16_f32 v198, v188, v189
    v_cvt_pk_bf16_f32 v199, v190, v191
    buffer_store_dwordx4 v[196:199], v54, s[52:55], s66 offen offset:1024 sc1
    s_waitcnt lgkmcnt(0)
    s_waitcnt vmcnt(11)
    s_barrier
    ds_read_b128 a[192:195], v208 offset:0
    ds_read_b128 a[196:199], v208 offset:1024
    ds_read_b64_tr_b16 a[200:201], v209 offset:0
    ds_read_b64_tr_b16 a[202:203], v209 offset:256
    ds_read_b64_tr_b16 a[204:205], v209 offset:512
    ds_read_b64_tr_b16 a[206:207], v209 offset:768
    s_waitcnt lgkmcnt(5)
    v_mfma_f32_32x32x16_bf16 v[96:111], a[192:195], v[144:147], v[64:79]
    s_waitcnt lgkmcnt(4)
    v_mfma_f32_32x32x16_bf16 v[112:127], a[196:199], v[148:151], v[64:79]
    ds_read_b64_tr_b16 v[152:153], v215 offset:0
    ds_read_b64_tr_b16 v[154:155], v215 offset:1024
    ds_read_b64_tr_b16 v[156:157], v215 offset:256
    ds_read_b64_tr_b16 v[158:159], v215 offset:1280
    ds_read_b64_tr_b16 v[192:193], v215 offset:2048
    ds_read_b64_tr_b16 v[194:195], v215 offset:3072
    ds_read_b64_tr_b16 v[196:197], v215 offset:2304
    ds_read_b64_tr_b16 v[198:199], v215 offset:3328
    ds_read_b128 a[192:195], v208 offset:4096
    s_nop 0
    v_exp_f32 v96, v96
    v_exp_f32 v97, v97
    v_exp_f32 v98, v98
    v_exp_f32 v99, v99
    v_exp_f32 v100, v100
    v_exp_f32 v101, v101
    ds_read_b64_tr_b16 a[208:209], v209 offset:1024
    ds_read_b64_tr_b16 a[210:211], v209 offset:1280
    v_exp_f32 v102, v102
    v_exp_f32 v103, v103
    v_exp_f32 v104, v104
    v_exp_f32 v105, v105
    v_exp_f32 v106, v106
    v_cvt_pk_bf16_f32 v128, v96, v97
    v_cvt_pk_bf16_f32 v129, v98, v99
    v_cvt_pk_bf16_f32 v130, v100, v101
    ds_read_b64_tr_b16 a[212:213], v209 offset:1536
    ds_read_b64_tr_b16 a[214:215], v209 offset:1792
    v_add_u32 v209, v209, v210
    v_exp_f32 v107, v107
    v_exp_f32 v108, v108
    v_exp_f32 v109, v109
    v_exp_f32 v110, v110
    v_exp_f32 v111, v111
    v_cvt_pk_bf16_f32 v131, v102, v103
    v_cvt_pk_bf16_f32 v132, v104, v105
    v_cvt_pk_bf16_f32 v133, v106, v107
    v_cvt_pk_bf16_f32 v134, v108, v109
    v_cvt_pk_bf16_f32 v135, v110, v111
    s_waitcnt lgkmcnt(4)
    v_mfma_f32_32x32x16_bf16 v[96:111], a[192:195], v[144:147], 0
    ds_read_b64_tr_b16 v[200:201], v215 offset:4096
    ds_read_b64_tr_b16 v[202:203], v215 offset:5120
    ds_read_b64_tr_b16 v[204:205], v215 offset:4352
    ds_read_b64_tr_b16 v[206:207], v215 offset:5376
    ds_read_b64_tr_b16 v[4:5], v215 offset:24576
    ds_read_b64_tr_b16 v[6:7], v215 offset:25600
    ds_read_b64_tr_b16 v[8:9], v215 offset:24832
    ds_read_b64_tr_b16 v[10:11], v215 offset:25856
    ds_read_b128 a[196:199], v208 offset:5120
    s_add_u32 m0, s80, 0
    s_nop 0
    buffer_load_dwordx4 v62, s[40:43], s100 offen  lds
    v_exp_f32 v112, v112
    v_exp_f32 v113, v113
    v_exp_f32 v114, v114
    v_exp_f32 v115, v115
    v_exp_f32 v116, v116
    v_exp_f32 v117, v117
    v_mfma_f32_32x32x16_bf16 v[160:175], a[200:203], v[128:131], 0
    ds_read_b64_tr_b16 a[200:201], v209 offset:0
    ds_read_b64_tr_b16 a[202:203], v209 offset:256
    buffer_load_dwordx4 v63, s[40:43], s100 offen offset:1024  lds
    s_add_u32 m0, s80, 2048
    v_exp_f32 v118, v118
    v_exp_f32 v119, v119
    v_exp_f32 v120, v120
    v_exp_f32 v121, v121
    v_exp_f32 v122, v122
    v_cvt_pk_bf16_f32 v136, v112, v113
    v_cvt_pk_bf16_f32 v137, v114, v115
    v_cvt_pk_bf16_f32 v138, v116, v117
    v_mfma_f32_32x32x16_bf16 v[160:175], a[204:207], v[132:135], v[160:175]
    ds_read_b64_tr_b16 a[204:205], v209 offset:512
    ds_read_b64_tr_b16 a[206:207], v209 offset:768
    s_add_u32 s81, s100, 16384
    buffer_load_dwordx4 v62, s[40:43], s81 offen  lds
    buffer_load_dwordx4 v63, s[40:43], s81 offen offset:1024  lds
    s_add_u32 m0, s80, 4096
    v_exp_f32 v123, v123
    v_exp_f32 v124, v124
    v_exp_f32 v125, v125
    v_exp_f32 v126, v126
    v_exp_f32 v127, v127
    v_cvt_pk_bf16_f32 v139, v118, v119
    v_cvt_pk_bf16_f32 v140, v120, v121
    v_cvt_pk_bf16_f32 v141, v122, v123
    v_cvt_pk_bf16_f32 v142, v124, v125
    v_cvt_pk_bf16_f32 v143, v126, v127
    s_waitcnt lgkmcnt(4)
    v_mfma_f32_32x32x16_bf16 v[112:127], a[196:199], v[148:151], 0
    ds_read_b64_tr_b16 v[12:13], v215 offset:26624
    ds_read_b64_tr_b16 v[14:15], v215 offset:27648
    ds_read_b64_tr_b16 v[16:17], v215 offset:26880
    ds_read_b64_tr_b16 v[18:19], v215 offset:27904
    ds_read_b128 a[192:195], v208 offset:8192
    buffer_load_dwordx4 v62, s[40:43], s101 offen  lds
    v_exp_f32 v96, v96
    v_exp_f32 v97, v97
    v_exp_f32 v98, v98
    v_exp_f32 v99, v99
    v_exp_f32 v100, v100
    v_exp_f32 v101, v101
    v_mfma_f32_32x32x16_bf16 v[176:191], a[208:211], v[136:139], 0
    ds_read_b64_tr_b16 a[208:209], v209 offset:1024
    ds_read_b64_tr_b16 a[210:211], v209 offset:1280
    buffer_load_dwordx4 v63, s[40:43], s101 offen offset:1024  lds
    s_add_u32 m0, s80, 24576
    s_add_u32 s81, s101, 16384
    buffer_load_dwordx4 v62, s[40:43], s81 offen  lds
    v_exp_f32 v102, v102
    v_exp_f32 v103, v103
    v_exp_f32 v104, v104
    v_exp_f32 v105, v105
    v_exp_f32 v106, v106
    v_cvt_pk_bf16_f32 v128, v96, v97
    v_cvt_pk_bf16_f32 v129, v98, v99
    v_cvt_pk_bf16_f32 v130, v100, v101
    v_mfma_f32_32x32x16_bf16 v[176:191], a[212:215], v[140:143], v[176:191]
    ds_read_b64_tr_b16 a[212:213], v209 offset:1536
    ds_read_b64_tr_b16 a[214:215], v209 offset:1792
    buffer_load_dwordx4 v63, s[40:43], s81 offen offset:1024  lds
    s_add_u32 m0, s80, 26624
    v_mov_b32 v1, 1
    s_mov_b32 s73, 16384
    s_waitcnt vmcnt(8)
    buffer_store_dword v1, v225, s[52:55], s73 offen sc1
    v_add_u32 v209, v209, v210
    v_exp_f32 v107, v107
    v_exp_f32 v108, v108
    v_exp_f32 v109, v109
    v_exp_f32 v110, v110
    v_exp_f32 v111, v111
    v_cvt_pk_bf16_f32 v131, v102, v103
    v_cvt_pk_bf16_f32 v132, v104, v105
    v_cvt_pk_bf16_f32 v133, v106, v107
    v_cvt_pk_bf16_f32 v134, v108, v109
    v_cvt_pk_bf16_f32 v135, v110, v111
    s_waitcnt lgkmcnt(4)
    v_mfma_f32_32x32x16_bf16 v[96:111], a[192:195], v[144:147], 0
    ds_read_b64_tr_b16 v[20:21], v215 offset:28672
    ds_read_b64_tr_b16 v[22:23], v215 offset:29696
    ds_read_b64_tr_b16 v[24:25], v215 offset:28928
    ds_read_b64_tr_b16 v[26:27], v215 offset:29952
    ds_read_b64_tr_b16 v[36:37], v216 offset:0
    ds_read_b64_tr_b16 v[38:39], v216 offset:1024
    ds_read_b64_tr_b16 v[40:41], v216 offset:256
    ds_read_b64_tr_b16 v[42:43], v216 offset:1280
    ds_read_b128 a[196:199], v208 offset:9216
    v_exp_f32 v112, v112
    v_exp_f32 v113, v113
    v_exp_f32 v114, v114
    v_exp_f32 v115, v115
    v_exp_f32 v116, v116
    v_exp_f32 v117, v117
    v_mfma_f32_32x32x16_bf16 v[160:175], a[200:203], v[128:131], v[160:175]
    ds_read_b64_tr_b16 a[200:201], v209 offset:0
    ds_read_b64_tr_b16 a[202:203], v209 offset:256
    buffer_load_dwordx4 v62, s[40:43], s17 offen  lds
    v_exp_f32 v118, v118
    v_exp_f32 v119, v119
    v_exp_f32 v120, v120
    v_exp_f32 v121, v121
    v_exp_f32 v122, v122
    v_cvt_pk_bf16_f32 v136, v112, v113
    v_cvt_pk_bf16_f32 v137, v114, v115
    v_cvt_pk_bf16_f32 v138, v116, v117
    v_mfma_f32_32x32x16_bf16 v[160:175], a[204:207], v[132:135], v[160:175]
    ds_read_b64_tr_b16 a[204:205], v209 offset:512
    ds_read_b64_tr_b16 a[206:207], v209 offset:768
    buffer_load_dwordx4 v63, s[40:43], s17 offen offset:1024  lds
    s_add_u32 m0, s80, 28672
    v_exp_f32 v123, v123
    v_exp_f32 v124, v124
    v_exp_f32 v125, v125
    v_exp_f32 v126, v126
    v_exp_f32 v127, v127
    v_cvt_pk_bf16_f32 v139, v118, v119
    v_cvt_pk_bf16_f32 v140, v120, v121
    v_cvt_pk_bf16_f32 v141, v122, v123
    v_cvt_pk_bf16_f32 v142, v124, v125
    v_cvt_pk_bf16_f32 v143, v126, v127
    s_waitcnt lgkmcnt(4)
    v_mfma_f32_32x32x16_bf16 v[112:127], a[196:199], v[148:151], 0
    ds_read_b64_tr_b16 v[44:45], v216 offset:2048
    ds_read_b64_tr_b16 v[46:47], v216 offset:3072
    ds_read_b64_tr_b16 v[48:49], v216 offset:2304
    ds_read_b64_tr_b16 v[50:51], v216 offset:3328
    ds_read_b64_tr_b16 v[240:241], v216 offset:4096
    ds_read_b64_tr_b16 v[242:243], v216 offset:5120
    ds_read_b64_tr_b16 v[244:245], v216 offset:4352
    ds_read_b64_tr_b16 v[246:247], v216 offset:5376
    ds_read_b128 a[192:195], v208 offset:12288
    s_add_u32 s81, s17, 16384
    buffer_load_dwordx4 v62, s[40:43], s81 offen  lds
    v_exp_f32 v96, v96
    v_exp_f32 v97, v97
    v_exp_f32 v98, v98
    v_exp_f32 v99, v99
    v_exp_f32 v100, v100
    v_exp_f32 v101, v101
    v_mfma_f32_32x32x16_bf16 v[176:191], a[208:211], v[136:139], v[176:191]
    ds_read_b64_tr_b16 a[208:209], v209 offset:1024
    ds_read_b64_tr_b16 a[210:211], v209 offset:1280
    buffer_load_dwordx4 v63, s[40:43], s81 offen offset:1024  lds
    s_add_u32 m0, s80, 49152
    s_nop 0
    buffer_load_dwordx4 v62, s[40:43], s14 offen  lds
    v_exp_f32 v102, v102
    v_exp_f32 v103, v103
    v_exp_f32 v104, v104
    v_exp_f32 v105, v105
    v_exp_f32 v106, v106
    v_cvt_pk_bf16_f32 v128, v96, v97
    v_cvt_pk_bf16_f32 v129, v98, v99
    v_cvt_pk_bf16_f32 v130, v100, v101
    v_mfma_f32_32x32x16_bf16 v[176:191], a[212:215], v[140:143], v[176:191]
    ds_read_b64_tr_b16 a[212:213], v209 offset:1536
    ds_read_b64_tr_b16 a[214:215], v209 offset:1792
    buffer_load_dwordx4 v63, s[40:43], s14 offen offset:1024  lds
    s_add_u32 m0, s80, 51200
    buffer_load_dword v58, v214, s[52:55], 0 offen sc1
    v_add_u32 v209, v209, v210
    v_exp_f32 v107, v107
    v_exp_f32 v108, v108
    v_exp_f32 v109, v109
    v_exp_f32 v110, v110
    v_exp_f32 v111, v111
    v_cvt_pk_bf16_f32 v131, v102, v103
    v_cvt_pk_bf16_f32 v132, v104, v105
    v_cvt_pk_bf16_f32 v133, v106, v107
    v_cvt_pk_bf16_f32 v134, v108, v109
    v_cvt_pk_bf16_f32 v135, v110, v111
    s_waitcnt lgkmcnt(4)
    v_mfma_f32_32x32x16_bf16 v[96:111], a[192:195], v[144:147], 0
    ds_read_b64_tr_b16 v[248:249], v216 offset:24576
    ds_read_b64_tr_b16 v[250:251], v216 offset:25600
    ds_read_b64_tr_b16 v[252:253], v216 offset:24832
    ds_read_b64_tr_b16 v[254:255], v216 offset:25856
    ds_read_b128 a[196:199], v208 offset:13312
    s_add_u32 s81, s14, 16384
    buffer_load_dwordx4 v62, s[40:43], s81 offen  lds
    v_exp_f32 v112, v112
    v_exp_f32 v113, v113
    v_exp_f32 v114, v114
    v_exp_f32 v115, v115
    v_exp_f32 v116, v116
    v_exp_f32 v117, v117
    v_mfma_f32_32x32x16_bf16 v[160:175], a[200:203], v[128:131], v[160:175]
    ds_read_b64_tr_b16 a[200:201], v209 offset:0
    ds_read_b64_tr_b16 a[202:203], v209 offset:256
    buffer_load_dwordx4 v63, s[40:43], s81 offen offset:1024  lds
    s_add_u32 m0, s80, 53248
    v_exp_f32 v118, v118
    v_exp_f32 v119, v119
    v_exp_f32 v120, v120
    v_exp_f32 v121, v121
    v_exp_f32 v122, v122
    v_cvt_pk_bf16_f32 v136, v112, v113
    v_cvt_pk_bf16_f32 v137, v114, v115
    v_cvt_pk_bf16_f32 v138, v116, v117
    v_mfma_f32_32x32x16_bf16 v[160:175], a[204:207], v[132:135], v[160:175]
    ds_read_b64_tr_b16 a[204:205], v209 offset:512
    ds_read_b64_tr_b16 a[206:207], v209 offset:768
    buffer_load_dwordx4 v62, s[40:43], s15 offen  lds
    buffer_load_dwordx4 v63, s[40:43], s15 offen offset:1024  lds
    s_add_u32 m0, s80, 73728
    v_exp_f32 v123, v123
    v_exp_f32 v124, v124
    v_exp_f32 v125, v125
    v_exp_f32 v126, v126
    v_exp_f32 v127, v127
    v_cvt_pk_bf16_f32 v139, v118, v119
    v_cvt_pk_bf16_f32 v140, v120, v121
    v_cvt_pk_bf16_f32 v141, v122, v123
    v_cvt_pk_bf16_f32 v142, v124, v125
    v_cvt_pk_bf16_f32 v143, v126, v127
    s_waitcnt lgkmcnt(4)
    v_mfma_f32_32x32x16_bf16 v[112:127], a[196:199], v[148:151], 0
    ds_read_b128 a[192:195], v208 offset:16384
    v_exp_f32 v96, v96
    v_exp_f32 v97, v97
    v_exp_f32 v98, v98
    v_exp_f32 v99, v99
    v_exp_f32 v100, v100
    v_exp_f32 v101, v101
    v_mfma_f32_32x32x16_bf16 v[176:191], a[208:211], v[136:139], v[176:191]
    ds_read_b64_tr_b16 a[208:209], v209 offset:1024
    ds_read_b64_tr_b16 a[210:211], v209 offset:1280
    s_add_u32 s81, s15, 16384
    buffer_load_dwordx4 v62, s[40:43], s81 offen  lds
    v_exp_f32 v102, v102
    v_exp_f32 v103, v103
    v_exp_f32 v104, v104
    v_exp_f32 v105, v105
    v_exp_f32 v106, v106
    v_cvt_pk_bf16_f32 v128, v96, v97
    v_cvt_pk_bf16_f32 v129, v98, v99
    v_cvt_pk_bf16_f32 v130, v100, v101
    v_mfma_f32_32x32x16_bf16 v[176:191], a[212:215], v[140:143], v[176:191]
    ds_read_b64_tr_b16 a[212:213], v209 offset:1536
    ds_read_b64_tr_b16 a[214:215], v209 offset:1792
    buffer_load_dwordx4 v63, s[40:43], s81 offen offset:1024  lds
    v_add_u32 v209, v209, v210
    v_exp_f32 v107, v107
    v_exp_f32 v108, v108
    v_exp_f32 v109, v109
    v_exp_f32 v110, v110
    v_exp_f32 v111, v111
    v_cvt_pk_bf16_f32 v131, v102, v103
    v_cvt_pk_bf16_f32 v132, v104, v105
    v_cvt_pk_bf16_f32 v133, v106, v107
    v_cvt_pk_bf16_f32 v134, v108, v109
    v_cvt_pk_bf16_f32 v135, v110, v111
    s_waitcnt lgkmcnt(4)
    v_mfma_f32_32x32x16_bf16 v[96:111], a[192:195], v[144:147], 0
    ds_read_b128 a[196:199], v208 offset:17408
    s_waitcnt vmcnt(6)
    v_cmp_eq_u32 vcc, 0, v58
    s_nop 0
    s_cbranch_vccnz L_spin_h
L_ok_h:
    v_and_b32 v214, -5, v214
    v_add_u32 v214, 8192, v214
    v_exp_f32 v112, v112
    v_exp_f32 v113, v113
    v_exp_f32 v114, v114
    v_exp_f32 v115, v115
    v_exp_f32 v116, v116
    v_exp_f32 v117, v117
    v_mfma_f32_32x32x16_bf16 v[160:175], a[200:203], v[128:131], v[160:175]
    ds_read_b64_tr_b16 a[200:201], v209 offset:0
    ds_read_b64_tr_b16 a[202:203], v209 offset:256
    buffer_load_dwordx4 a[0:3], v221, s[52:55], s18 offen sc1
    v_exp_f32 v118, v118
    v_exp_f32 v119, v119
    v_exp_f32 v120, v120
    v_exp_f32 v121, v121
    v_exp_f32 v122, v122
    v_cvt_pk_bf16_f32 v136, v112, v113
    v_cvt_pk_bf16_f32 v137, v114, v115
    v_cvt_pk_bf16_f32 v138, v116, v117
    v_mfma_f32_32x32x16_bf16 v[160:175], a[204:207], v[132:135], v[160:175]
    ds_read_b64_tr_b16 a[204:205], v209 offset:512
    ds_read_b64_tr_b16 a[206:207], v209 offset:768
    buffer_load_dwordx4 a[4:7], v222, s[52:55], s18 offen sc1
    buffer_load_dwordx4 a[8:11], v221, s[52:55], s18 offen offset:1024 sc1
    v_exp_f32 v123, v123
    v_exp_f32 v124, v124
    v_exp_f32 v125, v125
    v_exp_f32 v126, v126
    v_exp_f32 v127, v127
    v_cvt_pk_bf16_f32 v139, v118, v119
    v_cvt_pk_bf16_f32 v140, v120, v121
    v_cvt_pk_bf16_f32 v141, v122, v123
    v_cvt_pk_bf16_f32 v142, v124, v125
    v_cvt_pk_bf16_f32 v143, v126, v127
    s_waitcnt lgkmcnt(4)
    v_mfma_f32_32x32x16_bf16 v[112:127], a[196:199], v[148:151], 0
    ds_read_b128 a[192:195], v208 offset:20480
    buffer_load_dwordx4 a[12:15], v222, s[52:55], s18 offen offset:1024 sc1
    v_exp_f32 v96, v96
    v_exp_f32 v97, v97
    v_exp_f32 v98, v98
    v_exp_f32 v99, v99
    v_exp_f32 v100, v100
    v_exp_f32 v101, v101
    v_mfma_f32_32x32x16_bf16 v[176:191], a[208:211], v[136:139], v[176:191]
    ds_read_b64_tr_b16 a[208:209], v209 offset:1024
    ds_read_b64_tr_b16 a[210:211], v209 offset:1280
    buffer_load_dwordx4 a[16:19], v221, s[52:55], s19 offen sc1
    v_exp_f32 v102, v102
    v_exp_f32 v103, v103
    v_exp_f32 v104, v104
    v_exp_f32 v105, v105
    v_exp_f32 v106, v106
    v_cvt_pk_bf16_f32 v128, v96, v97
    v_cvt_pk_bf16_f32 v129, v98, v99
    v_cvt_pk_bf16_f32 v130, v100, v101
    v_mfma_f32_32x32x16_bf16 v[176:191], a[212:215], v[140:143], v[176:191]
    ds_read_b64_tr_b16 a[212:213], v209 offset:1536
    ds_read_b64_tr_b16 a[214:215], v209 offset:1792
    buffer_load_dwordx4 a[20:23], v222, s[52:55], s19 offen sc1
    buffer_load_dwordx4 a[24:27], v221, s[52:55], s19 offen offset:1024 sc1
    v_add_u32 v209, v209, v210
    v_exp_f32 v107, v107
    v_exp_f32 v108, v108
    v_exp_f32 v109, v109
    v_exp_f32 v110, v110
    v_exp_f32 v111, v111
    v_cvt_pk_bf16_f32 v131, v102, v103
    v_cvt_pk_bf16_f32 v132, v104, v105
    v_cvt_pk_bf16_f32 v133, v106, v107
    v_cvt_pk_bf16_f32 v134, v108, v109
    v_cvt_pk_bf16_f32 v135, v110, v111
    s_waitcnt lgkmcnt(4)
    v_mfma_f32_32x32x16_bf16 v[96:111], a[192:195], v[144:147], 0
    ds_read_b128 a[196:199], v208 offset:21504
    buffer_load_dwordx4 a[28:31], v222, s[52:55], s19 offen offset:1024 sc1
    v_exp_f32 v112, v112
    v_exp_f32 v113, v113
    v_exp_f32 v114, v114
    v_exp_f32 v115, v115
    v_exp_f32 v116, v116
    v_exp_f32 v117, v117
    v_mfma_f32_32x32x16_bf16 v[160:175], a[200:203], v[128:131], v[160:175]
    ds_read_b64_tr_b16 a[200:201], v209 offset:0
    ds_read_b64_tr_b16 a[202:203], v209 offset:256
    buffer_load_dwordx4 a[32:35], v221, s[52:55], s20 offen sc1
    v_exp_f32 v118, v118
    v_exp_f32 v119, v119
    v_exp_f32 v120, v120
    v_exp_f32 v121, v121
    v_exp_f32 v122, v122
    v_cvt_pk_bf16_f32 v136, v112, v113
    v_cvt_pk_bf16_f32 v137, v114, v115
    v_cvt_pk_bf16_f32 v138, v116, v117
    v_mfma_f32_32x32x16_bf16 v[160:175], a[204:207], v[132:135], v[160:175]
    ds_read_b64_tr_b16 a[204:205], v209 offset:512
    ds_read_b64_tr_b16 a[206:207], v209 offset:768
    buffer_load_dwordx4 a[36:39], v222, s[52:55], s20 offen sc1
    v_exp_f32 v123, v123
    v_exp_f32 v124, v124
    v_exp_f32 v125, v125
    v_exp_f32 v126, v126
    v_exp_f32 v127, v127
    v_cvt_pk_bf16_f32 v139, v118, v119
    v_cvt_pk_bf16_f32 v140, v120, v121
    v_cvt_pk_bf16_f32 v141, v122, v123
    v_cvt_pk_bf16_f32 v142, v124, v125
    v_cvt_pk_bf16_f32 v143, v126, v127
    s_waitcnt lgkmcnt(4)
    v_mfma_f32_32x32x16_bf16 v[112:127], a[196:199], v[148:151], 0
    ds_read_b128 a[192:195], v208 offset:24576
    buffer_load_dwordx4 a[40:43], v221, s[52:55], s20 offen offset:1024 sc1
    v_exp_f32 v96, v96
    v_exp_f32 v97, v97
    v_exp_f32 v98, v98
    v_exp_f32 v99, v99
    v_exp_f32 v100, v100
    v_exp_f32 v101, v101
    v_mfma_f32_32x32x16_bf16 v[176:191], a[208:211], v[136:139], v[176:191]
    ds_read_b64_tr_b16 a[208:209], v209 offset:1024
    ds_read_b64_tr_b16 a[210:211], v209 offset:1280
    buffer_load_dwordx4 a[44:47], v222, s[52:55], s20 offen offset:1024 sc1
    v_exp_f32 v102, v102
    v_exp_f32 v103, v103
    v_exp_f32 v104, v104
    v_exp_f32 v105, v105
    v_exp_f32 v106, v106
    v_cvt_pk_bf16_f32 v128, v96, v97
    v_cvt_pk_bf16_f32 v129, v98, v99
    v_cvt_pk_bf16_f32 v130, v100, v101
    v_mfma_f32_32x32x16_bf16 v[176:191], a[212:215], v[140:143], v[176:191]
    ds_read_b64_tr_b16 a[212:213], v209 offset:1536
    ds_read_b64_tr_b16 a[214:215], v209 offset:1792
    buffer_load_dwordx4 a[48:51], v221, s[52:55], s21 offen sc1
    buffer_load_dwordx4 a[52:55], v222, s[52:55], s21 offen sc1
    v_add_u32 v209, v209, v210
    v_exp_f32 v107, v107
    v_exp_f32 v108, v108
    v_exp_f32 v109, v109
    v_exp_f32 v110, v110
    v_exp_f32 v111, v111
    v_cvt_pk_bf16_f32 v131, v102, v103
    v_cvt_pk_bf16_f32 v132, v104, v105
    v_cvt_pk_bf16_f32 v133, v106, v107
    v_cvt_pk_bf16_f32 v134, v108, v109
    v_cvt_pk_bf16_f32 v135, v110, v111
    s_waitcnt lgkmcnt(4)
    v_mfma_f32_32x32x16_bf16 v[96:111], a[192:195], v[144:147], 0
    ds_read_b128 a[196:199], v208 offset:25600
    buffer_load_dwordx4 a[56:59], v221, s[52:55], s21 offen offset:1024 sc1
    v_exp_f32 v112, v112
    v_exp_f32 v113, v113
    v_exp_f32 v114, v114
    v_exp_f32 v115, v115
    v_exp_f32 v116, v116
    v_exp_f32 v117, v117
    v_mfma_f32_32x32x16_bf16 v[160:175], a[200:203], v[128:131], v[160:175]
    ds_read_b64_tr_b16 a[200:201], v209 offset:0
    ds_read_b64_tr_b16 a[202:203], v209 offset:256
    buffer_load_dwordx4 a[60:63], v222, s[52:55], s21 offen offset:1024 sc1
    v_exp_f32 v118, v118
    v_exp_f32 v119, v119
    v_exp_f32 v120, v120
    v_exp_f32 v121, v121
    v_exp_f32 v122, v122
    v_cvt_pk_bf16_f32 v136, v112, v113
    v_cvt_pk_bf16_f32 v137, v114, v115
    v_cvt_pk_bf16_f32 v138, v116, v117
    v_mfma_f32_32x32x16_bf16 v[160:175], a[204:207], v[132:135], v[160:175]
    ds_read_b64_tr_b16 a[204:205], v209 offset:512
    ds_read_b64_tr_b16 a[206:207], v209 offset:768
    buffer_load_dwordx4 a[64:67], v221, s[52:55], s22 offen sc1
    buffer_load_dword v58, v214, s[52:55], 0 offen sc1
    v_exp_f32 v123, v123
    v_exp_f32 v124, v124
    v_exp_f32 v125, v125
    v_exp_f32 v126, v126
    v_exp_f32 v127, v127
    v_cvt_pk_bf16_f32 v139, v118, v119
    v_cvt_pk_bf16_f32 v140, v120, v121
    v_cvt_pk_bf16_f32 v141, v122, v123
    v_cvt_pk_bf16_f32 v142, v124, v125
    v_cvt_pk_bf16_f32 v143, v126, v127
    s_waitcnt lgkmcnt(4)
    v_mfma_f32_32x32x16_bf16 v[112:127], a[196:199], v[148:151], 0
    ds_read_b128 a[192:195], v208 offset:28672
    buffer_load_dwordx4 a[68:71], v222, s[52:55], s22 offen sc1
    v_exp_f32 v96, v96
    v_exp_f32 v97, v97
    v_exp_f32 v98, v98
    v_exp_f32 v99, v99
    v_exp_f32 v100, v100
    v_exp_f32 v101, v101
    v_mfma_f32_32x32x16_bf16 v[176:191], a[208:211], v[136:139], v[176:191]
    ds_read_b64_tr_b16 a[208:209], v209 offset:1024
    ds_read_b64_tr_b16 a[210:211], v209 offset:1280
    buffer_load_dwordx4 a[72:75], v221, s[52:55], s22 offen offset:1024 sc1
    v_exp_f32 v102, v102
    v_exp_f32 v103, v103
    v_exp_f32 v104, v104
    v_exp_f32 v105, v105
    v_exp_f32 v106, v106
    v_cvt_pk_bf16_f32 v128, v96, v97
    v_cvt_pk_bf16_f32 v129, v98, v99
    v_cvt_pk_bf16_f32 v130, v100, v101
    v_mfma_f32_32x32x16_bf16 v[176:191], a[212:215], v[140:143], v[176:191]
    ds_read_b64_tr_b16 a[212:213], v209 offset:1536
    ds_read_b64_tr_b16 a[214:215], v209 offset:1792
    buffer_load_dwordx4 a[76:79], v222, s[52:55], s22 offen offset:1024 sc1
    buffer_load_dwordx4 a[80:83], v221, s[52:55], s23 offen sc1
    v_add_u32 v209, v209, v210
    v_exp_f32 v107, v107
    v_exp_f32 v108, v108
    v_exp_f32 v109, v109
    v_exp_f32 v110, v110
    v_exp_f32 v111, v111
    v_cvt_pk_bf16_f32 v131, v102, v103
    v_cvt_pk_bf16_f32 v132, v104, v105
    v_cvt_pk_bf16_f32 v133, v106, v107
    v_cvt_pk_bf16_f32 v134, v108, v109
    v_cvt_pk_bf16_f32 v135, v110, v111
    s_waitcnt lgkmcnt(4)
    v_mfma_f32_32x32x16_bf16 v[96:111], a[192:195], v[144:147], 0
    ds_read_b128 a[196:199], v208 offset:29696
    buffer_load_dwordx4 a[84:87], v222, s[52:55], s23 offen sc1
    v_exp_f32 v112, v112
    v_exp_f32 v113, v113
    v_exp_f32 v114, v114
    v_exp_f32 v115, v115
    v_exp_f32 v116, v116
    v_exp_f32 v117, v117
    v_mfma_f32_32x32x16_bf16 v[160:175], a[200:203], v[128:131], v[160:175]
    ds_read_b64_tr_b16 a[200:201], v209 offset:0
    ds_read_b64_tr_b16 a[202:203], v209 offset:256
    buffer_load_dwordx4 a[88:91], v221, s[52:55], s23 offen offset:1024 sc1
    v_exp_f32 v118, v118
    v_exp_f32 v119, v119
    v_exp_f32 v120, v120
    v_exp_f32 v121, v121
    v_exp_f32 v122, v122
    v_cvt_pk_bf16_f32 v136, v112, v113
    v_cvt_pk_bf16_f32 v137, v114, v115
    v_cvt_pk_bf16_f32 v138, v116, v117
    v_mfma_f32_32x32x16_bf16 v[160:175], a[204:207], v[132:135], v[160:175]
    ds_read_b64_tr_b16 a[204:205], v209 offset:512
    ds_read_b64_tr_b16 a[206:207], v209 offset:768
    buffer_load_dwordx4 a[92:95], v222, s[52:55], s23 offen offset:1024 sc1
    v_exp_f32 v123, v123
    v_exp_f32 v124, v124
    v_exp_f32 v125, v125
    v_exp_f32 v126, v126
    v_exp_f32 v127, v127
    v_cvt_pk_bf16_f32 v139, v118, v119
    v_cvt_pk_bf16_f32 v140, v120, v121
    v_cvt_pk_bf16_f32 v141, v122, v123
    v_cvt_pk_bf16_f32 v142, v124, v125
    v_cvt_pk_bf16_f32 v143, v126, v127
    s_waitcnt lgkmcnt(4)
    v_mfma_f32_32x32x16_bf16 v[112:127], a[196:199], v[148:151], 0
    ds_read_b128 a[192:195], v208 offset:32768
    buffer_load_dwordx4 a[96:99], v221, s[52:55], s92 offen sc1
    v_exp_f32 v96, v96
    v_exp_f32 v97, v97
    v_exp_f32 v98, v98
    v_exp_f32 v99, v99
    v_exp_f32 v100, v100
    v_exp_f32 v101, v101
    v_mfma_f32_32x32x16_bf16 v[176:191], a[208:211], v[136:139], v[176:191]
    ds_read_b64_tr_b16 a[208:209], v209 offset:1024
    ds_read_b64_tr_b16 a[210:211], v209 offset:1280
    buffer_load_dwordx4 a[100:103], v222, s[52:55], s92 offen sc1
    buffer_load_dwordx4 a[104:107], v221, s[52:55], s92 offen offset:1024 sc1
    v_exp_f32 v102, v102
    v_exp_f32 v103, v103
    v_exp_f32 v104, v104
    v_exp_f32 v105, v105
    v_exp_f32 v106, v106
    v_cvt_pk_bf16_f32 v128, v96, v97
    v_cvt_pk_bf16_f32 v129, v98, v99
    v_cvt_pk_bf16_f32 v130, v100, v101
    v_mfma_f32_32x32x16_bf16 v[176:191], a[212:215], v[140:143], v[176:191]
    ds_read_b64_tr_b16 a[212:213], v209 offset:1536
    ds_read_b64_tr_b16 a[214:215], v209 offset:1792
    buffer_load_dwordx4 a[108:111], v222, s[52:55], s92 offen offset:1024 sc1
    s_waitcnt vmcnt(11)
    v_cmp_eq_u32 vcc, 0, v58
    s_nop 0
    s_cbranch_vccnz L_spin_h2
L_ok_h2:
    v_add_u32 v214, 8192, v214
    v_add_u32 v209, v209, v210
    v_exp_f32 v107, v107
    v_exp_f32 v108, v108
    v_exp_f32 v109, v109
    v_exp_f32 v110, v110
    v_exp_f32 v111, v111
    v_cvt_pk_bf16_f32 v131, v102, v103
    v_cvt_pk_bf16_f32 v132, v104, v105
    v_cvt_pk_bf16_f32 v133, v106, v107
    v_cvt_pk_bf16_f32 v134, v108, v109
    v_cvt_pk_bf16_f32 v135, v110, v111
    s_waitcnt lgkmcnt(4)
    v_mfma_f32_32x32x16_bf16 v[96:111], a[192:195], v[144:147], v[80:95]
    ds_read_b128 a[196:199], v208 offset:33792
    buffer_load_dwordx4 a[112:115], v221, s[52:55], s93 offen sc1
    v_exp_f32 v112, v112
    v_exp_f32 v113, v113
    v_exp_f32 v114, v114
    v_exp_f32 v115, v115
    v_exp_f32 v116, v116
    v_exp_f32 v117, v117
    v_mfma_f32_32x32x16_bf16 v[160:175], a[200:203], v[128:131], v[160:175]
    ds_read_b64_tr_b16 a[200:201], v209 offset:0
    ds_read_b64_tr_b16 a[202:203], v209 offset:256
    buffer_load_dwordx4 a[116:119], v222, s[52:55], s93 offen sc1
    v_exp_f32 v118, v118
    v_exp_f32 v119, v119
    v_exp_f32 v120, v120
    v_exp_f32 v121, v121
    v_exp_f32 v122, v122
    v_cvt_pk_bf16_f32 v136, v112, v113
    v_cvt_pk_bf16_f32 v137, v114, v115
    v_cvt_pk_bf16_f32 v138, v116, v117
    v_mfma_f32_32x32x16_bf16 v[160:175], a[204:207], v[132:135], v[160:175]
    ds_read_b64_tr_b16 a[204:205], v209 offset:512
    ds_read_b64_tr_b16 a[206:207], v209 offset:768
    buffer_load_dwordx4 a[120:123], v221, s[52:55], s93 offen offset:1024 sc1
    buffer_load_dwordx4 a[124:127], v222, s[52:55], s93 offen offset:1024 sc1
    v_exp_f32 v123, v123
    v_exp_f32 v124, v124
    v_exp_f32 v125, v125
    v_exp_f32 v126, v126
    v_exp_f32 v127, v127
    v_cvt_pk_bf16_f32 v139, v118, v119
    v_cvt_pk_bf16_f32 v140, v120, v121
    v_cvt_pk_bf16_f32 v141, v122, v123
    v_cvt_pk_bf16_f32 v142, v124, v125
    v_cvt_pk_bf16_f32 v143, v126, v127
    s_waitcnt lgkmcnt(4)
    v_mfma_f32_32x32x16_bf16 v[112:127], a[196:199], v[148:151], v[80:95]
    buffer_load_dwordx4 a[128:131], v221, s[52:55], s64 offen sc1
    v_exp_f32 v96, v96
    v_exp_f32 v97, v97
    v_exp_f32 v98, v98
    v_exp_f32 v99, v99
    v_exp_f32 v100, v100
    v_exp_f32 v101, v101
    v_mfma_f32_32x32x16_bf16 v[176:191], a[208:211], v[136:139], v[176:191]
    ds_read_b64_tr_b16 a[208:209], v209 offset:1024
    ds_read_b64_tr_b16 a[210:211], v209 offset:1280
    buffer_load_dwordx4 a[132:135], v222, s[52:55], s64 offen sc1
    v_exp_f32 v102, v102
    v_exp_f32 v103, v103
    v_exp_f32 v104, v104
    v_exp_f32 v105, v105
    v_exp_f32 v106, v106
    v_cvt_pk_bf16_f32 v128, v96, v97
    v_cvt_pk_bf16_f32 v129, v98, v99
    v_cvt_pk_bf16_f32 v130, v100, v101
    v_mfma_f32_32x32x16_bf16 v[176:191], a[212:215], v[140:143], v[176:191]
    ds_read_b64_tr_b16 a[212:213], v209 offset:1536
    ds_read_b64_tr_b16 a[214:215], v209 offset:1792
    buffer_load_dwordx4 a[136:139], v221, s[52:55], s64 offen offset:1024 sc1
    buffer_load_dwordx4 a[140:143], v222, s[52:55], s64 offen offset:1024 sc1
    v_add_u32 v209, v209, v210
    v_exp_f32 v107, v107
    v_exp_f32 v108, v108
    v_exp_f32 v109, v109
    v_exp_f32 v110, v110
    v_exp_f32 v111, v111
    v_cvt_pk_bf16_f32 v131, v102, v103
    v_cvt_pk_bf16_f32 v132, v104, v105
    v_cvt_pk_bf16_f32 v133, v106, v107
    v_cvt_pk_bf16_f32 v134, v108, v109
    v_cvt_pk_bf16_f32 v135, v110, v111
    buffer_load_dwordx4 a[144:147], v221, s[52:55], s65 offen sc1
    v_exp_f32 v112, v112
    v_exp_f32 v113, v113
    v_exp_f32 v114, v114
    v_exp_f32 v115, v115
    v_exp_f32 v116, v116
    v_exp_f32 v117, v117
    s_waitcnt lgkmcnt(6)
    v_mfma_f32_32x32x16_bf16 v[160:175], a[200:203], v[128:131], v[160:175]
    buffer_load_dwordx4 a[148:151], v222, s[52:55], s65 offen sc1
    v_exp_f32 v118, v118
    v_exp_f32 v119, v119
    v_exp_f32 v120, v120
    v_exp_f32 v121, v121
    v_exp_f32 v122, v122
    v_cvt_pk_bf16_f32 v136, v112, v113
    v_cvt_pk_bf16_f32 v137, v114, v115
    v_cvt_pk_bf16_f32 v138, v116, v117
    s_waitcnt lgkmcnt(4)
    v_mfma_f32_32x32x16_bf16 v[160:175], a[204:207], v[132:135], v[160:175]
    buffer_load_dwordx4 a[152:155], v221, s[52:55], s65 offen offset:1024 sc1
    buffer_load_dwordx4 a[156:159], v222, s[52:55], s65 offen offset:1024 sc1
    v_exp_f32 v123, v123
    v_exp_f32 v124, v124
    v_exp_f32 v125, v125
    v_exp_f32 v126, v126
    v_exp_f32 v127, v127
    v_cvt_pk_bf16_f32 v139, v118, v119
    v_cvt_pk_bf16_f32 v140, v120, v121
    v_cvt_pk_bf16_f32 v141, v122, v123
    v_cvt_pk_bf16_f32 v142, v124, v125
    v_cvt_pk_bf16_f32 v143, v126, v127
    s_waitcnt lgkmcnt(2)
    v_mfma_f32_32x32x16_bf16 v[176:191], a[208:211], v[136:139], v[176:191]
    s_waitcnt lgkmcnt(0)
    v_mfma_f32_32x32x16_bf16 v[176:191], a[212:215], v[140:143], v[176:191]
    v_rcp_f32 v2, v168
    s_nop 0
    v_mul_f32 v160, v160, v2
    v_mul_f32 v161, v161, v2
    v_mul_f32 v162, v162, v2
    v_mul_f32 v163, v163, v2
    v_mul_f32 v164, v164, v2
    v_mul_f32 v165, v165, v2
    v_mul_f32 v166, v166, v2
    v_mul_f32 v167, v167, v2
    v_cvt_pk_bf16_f32 v172, v160, v161
    v_cvt_pk_bf16_f32 v173, v162, v163
    v_cvt_pk_bf16_f32 v174, v164, v165
    v_cvt_pk_bf16_f32 v175, v166, v167
    v_min_u32 v172, -2, v172
    s_mov_b32 s73, 0x2b800000
    s_mov_b32 s74, 0x53800000
    v_min_f32 v1, v168, v184
    v_max_f32 v2, v168, v184
    v_cmp_nle_f32 vcc, s73, v1
    v_cmp_nge_f32 s[4:5], s74, v2
    v_cmp_u_f32 s[6:7], v168, v184
    s_or_b64 vcc, vcc, s[4:5]
    s_or_b64 vcc, vcc, s[6:7]
    s_cbranch_vccnz L_truemax
L_att_done:
    buffer_store_dwordx4 v[172:175], v211, s[52:55], 0 offen sc1
    s_lshl_b32 s79, s3, 14
    s_mul_i32 s73, s3, 10240
    s_sub_u32 s73, s73, 65536
    v_add_u32 v213, s73, v215
    v_mfma_f32_32x32x16_bf16 a[192:207], v[152:155], a[0:3], 0
    v_rcp_f32 v2, v184
    s_nop 0
    v_mul_f32 v176, v176, v2
    v_mul_f32 v177, v177, v2
    v_mul_f32 v178, v178, v2
    v_mfma_f32_32x32x16_bf16 a[208:223], v[152:155], a[4:7], 0
    v_mul_f32 v179, v179, v2
    v_mul_f32 v180, v180, v2
    v_mul_f32 v181, v181, v2
    v_mul_f32 v182, v182, v2
    v_mul_f32 v183, v183, v2
    v_mfma_f32_32x32x16_bf16 a[224:239], v[156:159], a[0:3], 0
    v_cvt_pk_bf16_f32 v188, v176, v177
    v_cvt_pk_bf16_f32 v189, v178, v179
    v_cvt_pk_bf16_f32 v190, v180, v181
    v_cvt_pk_bf16_f32 v191, v182, v183
    v_min_u32 v188, -2, v188
    v_mfma_f32_32x32x16_bf16 a[240:255], v[156:159], a[4:7], 0
    buffer_store_dwordx4 v[188:191], v211, s[52:55], 0 offen offset:1024 sc1
    s_barrier
    v_mfma_f32_32x32x16_bf16 a[192:207], v[192:195], a[8:11], a[192:207]
    buffer_load_dwordx4 a[160:163], v221, s[52:55], s16 offen sc1
    v_xor_b32 v232, 0, v226
    v_mfma_f32_32x32x16_bf16 a[208:223], v[192:195], a[12:15], a[208:223]
    v_xor_b32 v233, 32, v226
    v_xor_b32 v234, 64, v226
    v_mfma_f32_32x32x16_bf16 a[224:239], v[196:199], a[8:11], a[224:239]
    buffer_load_dwordx4 a[164:167], v222, s[52:55], s16 offen sc1
    v_xor_b32 v235, 96, v226
    v_mfma_f32_32x32x16_bf16 a[240:255], v[196:199], a[12:15], a[240:255]
    v_xor_b32 v236, 16, v227
    v_mfma_f32_32x32x16_bf16 a[192:207], v[200:203], a[16:19], a[192:207]
    buffer_load_dwordx4 a[168:171], v221, s[52:55], s16 offen offset:1024 sc1
    v_mfma_f32_32x32x16_bf16 a[208:223], v[200:203], a[20:23], a[208:223]
    v_mfma_f32_32x32x16_bf16 a[224:239], v[204:207], a[16:19], a[224:239]
    buffer_load_dwordx4 a[172:175], v222, s[52:55], s16 offen offset:1024 sc1
    v_mfma_f32_32x32x16_bf16 a[240:255], v[204:207], a[20:23], a[240:255]
    v_mfma_f32_32x32x16_bf16 a[192:207], v[4:7], a[24:27], a[192:207]
    s_add_u32 m0, s79, 0
    s_nop 0
    buffer_load_dwordx4 v219, s[44:47], s12 offen  lds
    v_mfma_f32_32x32x16_bf16 a[208:223], v[4:7], a[28:31], a[208:223]
    v_mfma_f32_32x32x16_bf16 a[224:239], v[8:11], a[24:27], a[224:239]
    buffer_load_dwordx4 v220, s[44:47], s12 offen offset:1024  lds
    s_add_u32 s12, s12, 16384
    s_and_b32 s12, s12, 0x1ffff
    v_mfma_f32_32x32x16_bf16 a[240:255], v[8:11], a[28:31], a[240:255]
    v_mfma_f32_32x32x16_bf16 a[192:207], v[12:15], a[32:35], a[192:207]
    s_add_u32 m0, s79, 2048
    s_nop 0
    buffer_load_dwordx4 v219, s[44:47], s12 offen  lds
    v_mfma_f32_32x32x16_bf16 a[208:223], v[12:15], a[36:39], a[208:223]
    v_mfma_f32_32x32x16_bf16 a[224:239], v[16:19], a[32:35], a[224:239]
    buffer_load_dwordx4 v220, s[44:47], s12 offen offset:1024  lds
    s_add_u32 s12, s12, 16384
    s_and_b32 s12, s12, 0x1ffff
    v_mfma_f32_32x32x16_bf16 a[240:255], v[16:19], a[36:39], a[240:255]
    v_mfma_f32_32x32x16_bf16 a[192:207], v[20:23], a[40:43], a[192:207]
    s_add_u32 m0, s79, 4096
    s_nop 0
    buffer_load_dwordx4 v219, s[44:47], s12 offen  lds
    v_mfma_f32_32x32x16_bf16 a[208:223], v[20:23], a[44:47], a[208:223]
    v_mfma_f32_32x32x16_bf16 a[224:239], v[24:27], a[40:43], a[224:239]
    buffer_load_dwordx4 v220, s[44:47], s12 offen offset:1024  lds
    s_add_u32 s12, s12, 16384
    s_and_b32 s12, s12, 0x1ffff
    v_mfma_f32_32x32x16_bf16 a[240:255], v[24:27], a[44:47], a[240:255]
    v_mfma_f32_32x32x16_bf16 a[192:207], v[36:39], a[48:51], a[192:207]
    s_add_u32 m0, s79, 6144
    s_nop 0
    buffer_load_dwordx4 v219, s[44:47], s12 offen  lds
    v_mfma_f32_32x32x16_bf16 a[208:223], v[36:39], a[52:55], a[208:223]
    v_mfma_f32_32x32x16_bf16 a[224:239], v[40:43], a[48:51], a[224:239]
    buffer_load_dwordx4 v220, s[44:47], s12 offen offset:1024  lds
    s_add_u32 s12, s12, 16384
    s_and_b32 s12, s12, 0x1ffff
    v_mfma_f32_32x32x16_bf16 a[240:255], v[40:43], a[52:55], a[240:255]
    v_mfma_f32_32x32x16_bf16 a[192:207], v[44:47], a[56:59], a[192:207]
    s_add_u32 m0, s79, 8192
    s_nop 0
    buffer_load_dwordx4 v219, s[44:47], s12 offen  lds
    v_mfma_f32_32x32x16_bf16 a[208:223], v[44:47], a[60:63], a[208:223]
    v_mfma_f32_32x32x16_bf16 a[224:239], v[48:51], a[56:59], a[224:239]
    buffer_load_dwordx4 v220, s[44:47], s12 offen offset:1024  lds
    s_add_u32 s12, s12, 16384
    s_and_b32 s12, s12, 0x1ffff
    v_mfma_f32_32x32x16_bf16 a[240:255], v[48:51], a[60:63], a[240:255]
    v_mfma_f32_32x32x16_bf16 a[192:207], v[240:243], a[64:67], a[192:207]
    s_add_u32 m0, s79, 10240
    s_nop 0
    buffer_load_dwordx4 v219, s[44:47], s12 offen  lds
    s_waitcnt vmcnt(39)
    v_mfma_f32_32x32x16_bf16 a[208:223], v[240:243], a[68:71], a[208:223]
    v_mfma_f32_32x32x16_bf16 a[224:239], v[244:247], a[64:67], a[224:239]
    buffer_load_dwordx4 v220, s[44:47], s12 offen offset:1024  lds
    s_add_u32 s12, s12, 16384
    s_and_b32 s12, s12, 0x1ffff
    v_mfma_f32_32x32x16_bf16 a[240:255], v[244:247], a[68:71], a[240:255]
    s_waitcnt vmcnt(39)
    v_mfma_f32_32x32x16_bf16 a[192:207], v[248:251], a[72:75], a[192:207]
    ds_read_b64_tr_b16 a[176:177], v216 offset:26624
    ds_read_b64_tr_b16 a[178:179], v216 offset:27648
    s_add_u32 m0, s79, 12288
    s_nop 0
    buffer_load_dwordx4 v219, s[44:47], s12 offen  lds
    s_waitcnt vmcnt(39)
    v_mfma_f32_32x32x16_bf16 a[208:223], v[248:251], a[76:79], a[208:223]
    ds_read_b64_tr_b16 a[180:181], v216 offset:26880
    ds_read_b64_tr_b16 a[182:183], v216 offset:27904
    v_mfma_f32_32x32x16_bf16 a[224:239], v[252:255], a[72:75], a[224:239]
    buffer_load_dwordx4 v220, s[44:47], s12 offen offset:1024  lds
    s_add_u32 s12, s12, 16384
    s_and_b32 s12, s12, 0x1ffff
    v_mfma_f32_32x32x16_bf16 a[240:255], v[252:255], a[76:79], a[240:255]
    s_waitcnt vmcnt(39) lgkmcnt(0)
    v_mfma_f32_32x32x16_bf16 a[192:207], a[176:179], a[80:83], a[192:207]
    ds_read_b64_tr_b16 a[184:185], v216 offset:28672
    ds_read_b64_tr_b16 a[186:187], v216 offset:29696
    s_add_u32 m0, s79, 14336
    s_nop 0
    buffer_load_dwordx4 v219, s[44:47], s12 offen  lds
    s_waitcnt vmcnt(39)
    v_mfma_f32_32x32x16_bf16 a[208:223], a[176:179], a[84:87], a[208:223]
    ds_read_b64_tr_b16 a[188:189], v216 offset:28928
    ds_read_b64_tr_b16 a[190:191], v216 offset:29952
    v_mfma_f32_32x32x16_bf16 a[224:239], a[180:183], a[80:83], a[224:239]
    buffer_load_dwordx4 v220, s[44:47], s12 offen offset:1024  lds
    s_add_u32 s12, s12, 16384
    s_and_b32 s12, s12, 0x1ffff
    v_mfma_f32_32x32x16_bf16 a[240:255], a[180:183], a[84:87], a[240:255]
    s_waitcnt vmcnt(39) lgkmcnt(0)
    v_mfma_f32_32x32x16_bf16 a[192:207], a[184:187], a[88:91], a[192:207]
    ds_read_b64_tr_b16 a[176:177], v215 offset:0
    ds_read_b64_tr_b16 a[178:179], v215 offset:1024
    s_waitcnt vmcnt(38)
    v_mfma_f32_32x32x16_bf16 a[208:223], a[184:187], a[92:95], a[208:223]
    ds_read_b64_tr_b16 a[180:181], v215 offset:256
    ds_read_b64_tr_b16 a[182:183], v215 offset:1280
    buffer_load_dwordx4 v[64:67], v223, s[52:55], s13 offen sc1
    s_add_u32 s13, s13, 1024
    s_and_b32 s13, s13, 0x1fff
    v_mfma_f32_32x32x16_bf16 a[224:239], a[188:191], a[88:91], a[224:239]
    v_mfma_f32_32x32x16_bf16 a[240:255], a[188:191], a[92:95], a[240:255]
    buffer_load_dwordx4 v[72:75], v223, s[52:55], s13 offen sc1
    s_add_u32 s13, s13, 1024
    s_and_b32 s13, s13, 0x1fff
    s_waitcnt vmcnt(39) lgkmcnt(0)
    v_mfma_f32_32x32x16_bf16 a[192:207], a[176:179], a[96:99], a[192:207]
    ds_read_b64_tr_b16 a[184:185], v215 offset:2048
    ds_read_b64_tr_b16 a[186:187], v215 offset:3072
    v_lshlrev_b32 v192, 16, v28
    s_waitcnt vmcnt(38)
    v_mfma_f32_32x32x16_bf16 a[208:223], a[176:179], a[100:103], a[208:223]
    ds_read_b64_tr_b16 a[188:189], v215 offset:2304
    ds_read_b64_tr_b16 a[190:191], v215 offset:3328
    buffer_load_dwordx4 v[80:83], v223, s[52:55], s13 offen sc1
    s_add_u32 s13, s13, 1024
    s_and_b32 s13, s13, 0x1fff
    v_and_b32 v193, 0xffff0000, v28
    v_mfma_f32_32x32x16_bf16 a[224:239], a[180:183], a[96:99], a[224:239]
    v_lshlrev_b32 v194, 16, v29
    v_mfma_f32_32x32x16_bf16 a[240:255], a[180:183], a[100:103], a[240:255]
    buffer_load_dwordx4 v[88:91], v223, s[52:55], s13 offen sc1
    s_add_u32 s13, s13, 1024
    s_and_b32 s13, s13, 0x1fff
    v_and_b32 v195, 0xffff0000, v29
    s_waitcnt vmcnt(39) lgkmcnt(0)
    v_mfma_f32_32x32x16_bf16 a[192:207], a[184:187], a[104:107], a[192:207]
    ds_read_b64_tr_b16 a[176:177], v215 offset:4096
    ds_read_b64_tr_b16 a[178:179], v215 offset:5120
    v_lshlrev_b32 v196, 16, v30
    s_waitcnt vmcnt(38)
    v_mfma_f32_32x32x16_bf16 a[208:223], a[184:187], a[108:111], a[208:223]
    ds_read_b64_tr_b16 a[180:181], v215 offset:4352
    ds_read_b64_tr_b16 a[182:183], v215 offset:5376
    v_and_b32 v197, 0xffff0000, v30
    v_mfma_f32_32x32x16_bf16 a[224:239], a[188:191], a[104:107], a[224:239]
    buffer_load_dwordx4 v[96:99], v223, s[52:55], s13 offen sc1
    s_add_u32 s13, s13, 1024
    s_and_b32 s13, s13, 0x1fff
    v_lshlrev_b32 v198, 16, v31
    v_mfma_f32_32x32x16_bf16 a[240:255], a[188:191], a[108:111], a[240:255]
    v_and_b32 v199, 0xffff0000, v31
    s_waitcnt vmcnt(38) lgkmcnt(0)
    v_mfma_f32_32x32x16_bf16 a[192:207], a[176:179], a[112:115], a[192:207]
    ds_read_b64_tr_b16 a[184:185], v215 offset:24576
    ds_read_b64_tr_b16 a[186:187], v215 offset:25600
    buffer_load_dwordx4 v[104:107], v223, s[52:55], s13 offen sc1
    s_add_u32 s13, s13, 1024
    s_and_b32 s13, s13, 0x1fff
    v_lshlrev_b32 v200, 16, v32
    s_waitcnt vmcnt(38)
    v_mfma_f32_32x32x16_bf16 a[208:223], a[176:179], a[116:119], a[208:223]
    ds_read_b64_tr_b16 a[188:189], v215 offset:24832
    ds_read_b64_tr_b16 a[190:191], v215 offset:25856
    v_and_b32 v201, 0xffff0000, v32
    v_mfma_f32_32x32x16_bf16 a[224:239], a[180:183], a[112:115], a[224:239]
    buffer_load_dwordx4 v[112:115], v223, s[52:55], s13 offen sc1
    s_add_u32 s13, s13, 1024
    s_and_b32 s13, s13, 0x1fff
    v_lshlrev_b32 v202, 16, v33
    v_mfma_f32_32x32x16_bf16 a[240:255], a[180:183], a[116:119], a[240:255]
    v_and_b32 v203, 0xffff0000, v33
    s_waitcnt vmcnt(38) lgkmcnt(0)
    v_mfma_f32_32x32x16_bf16 a[192:207], a[184:187], a[120:123], a[192:207]
    ds_read_b64_tr_b16 a[176:177], v215 offset:26624
    ds_read_b64_tr_b16 a[178:179], v215 offset:27648
    buffer_load_dwordx4 v[120:123], v223, s[52:55], s13 offen sc1
    s_add_u32 s13, s13, 1024
    s_and_b32 s13, s13, 0x1fff
    v_lshlrev_b32 v204, 16, v34
    s_waitcnt vmcnt(38)
    v_mfma_f32_32x32x16_bf16 a[208:223], a[184:187], a[124:127], a[208:223]
    ds_read_b64_tr_b16 a[180:181], v215 offset:26880
    ds_read_b64_tr_b16 a[182:183], v215 offset:27904
    v_and_b32 v205, 0xffff0000, v34
    v_mfma_f32_32x32x16_bf16 a[224:239], a[188:191], a[120:123], a[224:239]
    v_lshlrev_b32 v206, 16, v35
    v_mfma_f32_32x32x16_bf16 a[240:255], a[188:191], a[124:127], a[240:255]
    buffer_load_dwordx4 v[68:71], v224, s[52:55], s13 offen sc1
    s_add_u32 s13, s13, 1024
    s_and_b32 s13, s13, 0x1fff
    v_and_b32 v207, 0xffff0000, v35
    s_waitcnt vmcnt(38) lgkmcnt(0)
    v_mfma_f32_32x32x16_bf16 a[192:207], a[176:179], a[128:131], a[192:207]
    ds_read_b64_tr_b16 a[184:185], v215 offset:28672
    ds_read_b64_tr_b16 a[186:187], v215 offset:29696
    s_waitcnt vmcnt(37)
    v_mfma_f32_32x32x16_bf16 a[208:223], a[176:179], a[132:135], a[208:223]
    ds_read_b64_tr_b16 a[188:189], v215 offset:28928
    ds_read_b64_tr_b16 a[190:191], v215 offset:29952
    buffer_load_dwordx4 v[76:79], v224, s[52:55], s13 offen sc1
    s_add_u32 s13, s13, 1024
    s_and_b32 s13, s13, 0x1fff
    v_mfma_f32_32x32x16_bf16 a[224:239], a[180:183], a[128:131], a[224:239]
    v_mfma_f32_32x32x16_bf16 a[240:255], a[180:183], a[132:135], a[240:255]
    buffer_load_dwordx4 v[84:87], v224, s[52:55], s13 offen sc1
    s_add_u32 s13, s13, 1024
    s_and_b32 s13, s13, 0x1fff
    s_waitcnt vmcnt(38) lgkmcnt(0)
    v_mfma_f32_32x32x16_bf16 a[192:207], a[184:187], a[136:139], a[192:207]
    ds_read_b64_tr_b16 a[176:177], v216 offset:0
    ds_read_b64_tr_b16 a[178:179], v216 offset:1024
    s_waitcnt vmcnt(37)
    v_mfma_f32_32x32x16_bf16 a[208:223], a[184:187], a[140:143], a[208:223]
    ds_read_b64_tr_b16 a[180:181], v216 offset:256
    ds_read_b64_tr_b16 a[182:183], v216 offset:1280
    buffer_load_dwordx4 v[92:95], v224, s[52:55], s13 offen sc1
    s_add_u32 s13, s13, 1024
    s_and_b32 s13, s13, 0x1fff
    v_mfma_f32_32x32x16_bf16 a[224:239], a[188:191], a[136:139], a[224:239]
    v_mfma_f32_32x32x16_bf16 a[240:255], a[188:191], a[140:143], a[240:255]
    s_waitcnt vmcnt(37) lgkmcnt(0)
    v_mfma_f32_32x32x16_bf16 a[192:207], a[176:179], a[144:147], a[192:207]
    ds_read_b64_tr_b16 a[184:185], v216 offset:2048
    ds_read_b64_tr_b16 a[186:187], v216 offset:3072
    buffer_load_dwordx4 v[100:103], v224, s[52:55], s13 offen sc1
    s_add_u32 s13, s13, 1024
    s_and_b32 s13, s13, 0x1fff
    s_waitcnt vmcnt(37)
    v_mfma_f32_32x32x16_bf16 a[208:223], a[176:179], a[148:151], a[208:223]
    ds_read_b64_tr_b16 a[188:189], v216 offset:2304
    ds_read_b64_tr_b16 a[190:191], v216 offset:3328
    v_mfma_f32_32x32x16_bf16 a[224:239], a[180:183], a[144:147], a[224:239]
    buffer_load_dwordx4 v[108:111], v224, s[52:55], s13 offen sc1
    s_add_u32 s13, s13, 1024
    s_and_b32 s13, s13, 0x1fff
    v_mfma_f32_32x32x16_bf16 a[240:255], a[180:183], a[148:151], a[240:255]
    s_waitcnt vmcnt(37) lgkmcnt(0)
    v_mfma_f32_32x32x16_bf16 a[192:207], a[184:187], a[152:155], a[192:207]
    ds_read_b64_tr_b16 a[176:177], v216 offset:4096
    ds_read_b64_tr_b16 a[178:179], v216 offset:5120
    buffer_load_dwordx4 v[116:119], v224, s[52:55], s13 offen sc1
    s_add_u32 s13, s13, 1024
    s_and_b32 s13, s13, 0x1fff
    s_waitcnt vmcnt(37)
    v_mfma_f32_32x32x16_bf16 a[208:223], a[184:187], a[156:159], a[208:223]
    ds_read_b64_tr_b16 a[180:181], v216 offset:4352
    ds_read_b64_tr_b16 a[182:183], v216 offset:5376
    v_mfma_f32_32x32x16_bf16 a[224:239], a[188:191], a[152:155], a[224:239]
    buffer_load_dwordx4 v[124:127], v224, s[52:55], s13 offen sc1
    s_add_u32 s13, s13, 1024
    s_and_b32 s13, s13, 0x1fff
    v_mfma_f32_32x32x16_bf16 a[240:255], a[188:191], a[156:159], a[240:255]
    s_waitcnt vmcnt(35) lgkmcnt(0)
    v_mfma_f32_32x32x16_bf16 a[192:207], a[176:179], a[160:163], a[192:207]
    ds_read_b64_tr_b16 a[184:185], v216 offset:24576
    ds_read_b64_tr_b16 a[186:187], v216 offset:25600
    s_waitcnt vmcnt(34)
    v_mfma_f32_32x32x16_bf16 a[208:223], a[176:179], a[164:167], a[208:223]
    ds_read_b64_tr_b16 a[188:189], v216 offset:24832
    ds_read_b64_tr_b16 a[190:191], v216 offset:25856
    v_mfma_f32_32x32x16_bf16 a[224:239], a[180:183], a[160:163], a[224:239]
    v_mfma_f32_32x32x16_bf16 a[240:255], a[180:183], a[164:167], a[240:255]
    s_waitcnt vmcnt(33) lgkmcnt(0)
    v_mfma_f32_32x32x16_bf16 a[192:207], a[184:187], a[168:171], a[192:207]
    s_waitcnt vmcnt(30)
    ds_read_b64_tr_b16 a[0:1], v213 offset:0
    ds_read_b64_tr_b16 a[2:3], v213 offset:1024
    v_mfma_f32_32x32x16_bf16 a[208:223], a[184:187], a[172:175], a[208:223]
    ds_read_b64_tr_b16 a[4:5], v213 offset:256
    ds_read_b64_tr_b16 a[6:7], v213 offset:1280
    v_mfma_f32_32x32x16_bf16 a[224:239], a[188:191], a[168:171], a[224:239]
    s_waitcnt vmcnt(28)
    ds_read_b64_tr_b16 a[8:9], v213 offset:2048
    ds_read_b64_tr_b16 a[10:11], v213 offset:3072
    ds_read_b64_tr_b16 a[12:13], v213 offset:2304
    ds_read_b64_tr_b16 a[14:15], v213 offset:3328
    v_mfma_f32_32x32x16_bf16 a[240:255], a[188:191], a[172:175], a[240:255]
    s_waitcnt vmcnt(13)
    v_max3_u32 v1, v64, v72, v80
    s_waitcnt vmcnt(11)
    v_max3_u32 v1, v1, v88, v96
    s_waitcnt vmcnt(9)
    v_max3_u32 v1, v1, v104, v112
    s_waitcnt vmcnt(8)
    v_max_u32 v1, v1, v120
    v_cmp_eq_u32 vcc, -1, v1
    s_nop 0
    s_cbranch_vccnz L_spin_o0
L_ok_o0:
    s_waitcnt lgkmcnt(4)
    v_mfma_f32_32x32x16_bf16 a[192:207], a[0:3], v[64:67], a[192:207]
    ds_read_b64_tr_b16 a[16:17], v213 offset:4096
    ds_read_b64_tr_b16 a[18:19], v213 offset:5120
    ds_read_b64_tr_b16 a[20:21], v213 offset:4352
    ds_read_b64_tr_b16 a[22:23], v213 offset:5376
    v_mfma_f32_32x32x16_bf16 a[224:239], a[4:7], v[64:67], a[224:239]
    s_waitcnt lgkmcnt(4)
    v_mfma_f32_32x32x16_bf16 a[192:207], a[8:11], v[72:75], a[192:207]
    ds_read_b64_tr_b16 a[24:25], v213 offset:6144
    ds_read_b64_tr_b16 a[26:27], v213 offset:7168
    ds_read_b64_tr_b16 a[28:29], v213 offset:6400
    ds_read_b64_tr_b16 a[30:31], v213 offset:7424
    v_mfma_f32_32x32x16_bf16 a[224:239], a[12:15], v[72:75], a[224:239]
    s_waitcnt lgkmcnt(4)
    v_mfma_f32_32x32x16_bf16 a[192:207], a[16:19], v[80:83], a[192:207]
    ds_read_b64_tr_b16 a[32:33], v213 offset:8192
    ds_read_b64_tr_b16 a[34:35], v213 offset:9216
    ds_read_b64_tr_b16 a[36:37], v213 offset:8448
    ds_read_b64_tr_b16 a[38:39], v213 offset:9472
    v_mfma_f32_32x32x16_bf16 a[224:239], a[20:23], v[80:83], a[224:239]
    s_waitcnt lgkmcnt(4)
    v_mfma_f32_32x32x16_bf16 a[192:207], a[24:27], v[88:91], a[192:207]
    ds_read_b64_tr_b16 a[40:41], v213 offset:10240
    ds_read_b64_tr_b16 a[42:43], v213 offset:11264
    ds_read_b64_tr_b16 a[44:45], v213 offset:10496
    ds_read_b64_tr_b16 a[46:47], v213 offset:11520
    v_mfma_f32_32x32x16_bf16 a[224:239], a[28:31], v[88:91], a[224:239]
    s_waitcnt lgkmcnt(4)
    v_mfma_f32_32x32x16_bf16 a[192:207], a[32:35], v[96:99], a[192:207]
    ds_read_b64_tr_b16 a[48:49], v213 offset:12288
    ds_read_b64_tr_b16 a[50:51], v213 offset:13312
    ds_read_b64_tr_b16 a[52:53], v213 offset:12544
    ds_read_b64_tr_b16 a[54:55], v213 offset:13568
    v_mfma_f32_32x32x16_bf16 a[224:239], a[36:39], v[96:99], a[224:239]
    s_waitcnt lgkmcnt(4)
    v_mfma_f32_32x32x16_bf16 a[192:207], a[40:43], v[104:107], a[192:207]
    ds_read_b64_tr_b16 a[56:57], v213 offset:14336
    ds_read_b64_tr_b16 a[58:59], v213 offset:15360
    ds_read_b64_tr_b16 a[60:61], v213 offset:14592
    ds_read_b64_tr_b16 a[62:63], v213 offset:15616
    v_mfma_f32_32x32x16_bf16 a[224:239], a[44:47], v[104:107], a[224:239]
    s_waitcnt lgkmcnt(4)
    v_mfma_f32_32x32x16_bf16 a[192:207], a[48:51], v[112:115], a[192:207]
    v_mfma_f32_32x32x16_bf16 a[224:239], a[52:55], v[112:115], a[224:239]
    s_waitcnt lgkmcnt(0)
    v_mfma_f32_32x32x16_bf16 a[192:207], a[56:59], v[120:123], a[192:207]
    v_mfma_f32_32x32x16_bf16 a[224:239], a[60:63], v[120:123], a[224:239]
    s_waitcnt vmcnt(5)
    v_max3_u32 v1, v68, v76, v84
    s_waitcnt vmcnt(3)
    v_max3_u32 v1, v1, v92, v100
    s_waitcnt vmcnt(1)
    v_max3_u32 v1, v1, v108, v116
    s_waitcnt vmcnt(0)
    v_max_u32 v1, v1, v124
    v_cmp_eq_u32 vcc, -1, v1
    s_nop 0
    s_cbranch_vccnz L_spin_o1
L_ok_o1:
    v_mfma_f32_32x32x16_bf16 a[208:223], a[0:3], v[68:71], a[208:223]
    v_mfma_f32_32x32x16_bf16 a[208:223], a[8:11], v[76:79], a[208:223]
    ds_write_b128 v232, a[192:195] offset:0
    ds_write_b128 v233, a[196:199] offset:0
    ds_write_b128 v234, a[200:203] offset:0
    v_mfma_f32_32x32x16_bf16 a[208:223], a[16:19], v[84:87], a[208:223]
    ds_write_b128 v235, a[204:207] offset:0
    ds_write_b128 v232, a[224:227] offset:128
    v_mfma_f32_32x32x16_bf16 a[208:223], a[24:27], v[92:95], a[208:223]
    ds_write_b128 v233, a[228:231] offset:128
    ds_write_b128 v234, a[232:235] offset:128
    ds_write_b128 v235, a[236:239] offset:128
    v_mfma_f32_32x32x16_bf16 a[208:223], a[32:35], v[100:103], a[208:223]
    v_mfma_f32_32x32x16_bf16 a[208:223], a[40:43], v[108:111], a[208:223]
    s_waitcnt lgkmcnt(0)
    s_barrier
    v_mfma_f32_32x32x16_bf16 a[208:223], a[48:51], v[116:119], a[208:223]
    ds_read_b128 v[128:131], v227 offset:0
    ds_read_b128 v[132:135], v236 offset:0
    ds_read_b128 v[136:139], v227 offset:16384
    ds_read_b128 v[140:143], v236 offset:16384
    v_mfma_f32_32x32x16_bf16 a[208:223], a[56:59], v[124:127], a[208:223]
    ds_read_b128 v[144:147], v227 offset:32768
    ds_read_b128 v[148:151], v236 offset:32768
    ds_read_b128 v[152:155], v227 offset:49152
    ds_read_b128 v[156:159], v236 offset:49152
    v_mfma_f32_32x32x16_bf16 a[240:255], a[4:7], v[68:71], a[240:255]
    v_mfma_f32_32x32x16_bf16 a[240:255], a[12:15], v[76:79], a[240:255]
    s_waitcnt lgkmcnt(7)
    v_add_f32 v192, v192, v128
    v_add_f32 v193, v193, v129
    v_add_f32 v194, v194, v130
    v_add_f32 v195, v195, v131
    s_waitcnt lgkmcnt(6)
    v_add_f32 v196, v196, v132
    v_mfma_f32_32x32x16_bf16 a[240:255], a[20:23], v[84:87], a[240:255]
    v_add_f32 v197, v197, v133
    v_add_f32 v198, v198, v134
    v_add_f32 v199, v199, v135
    s_waitcnt lgkmcnt(5)
    v_add_f32 v192, v192, v136
    v_add_f32 v193, v193, v137
    v_add_f32 v194, v194, v138
    v_mfma_f32_32x32x16_bf16 a[240:255], a[28:31], v[92:95], a[240:255]
    v_add_f32 v195, v195, v139
    s_waitcnt lgkmcnt(4)
    v_add_f32 v196, v196, v140
    v_add_f32 v197, v197, v141
    v_add_f32 v198, v198, v142
    v_add_f32 v199, v199, v143
    v_mfma_f32_32x32x16_bf16 a[240:255], a[36:39], v[100:103], a[240:255]
    ds_write_b128 v232, a[208:211] offset:8192
    s_waitcnt lgkmcnt(4)
    v_add_f32 v192, v192, v144
    v_add_f32 v193, v193, v145
    v_add_f32 v194, v194, v146
    v_add_f32 v195, v195, v147
    s_waitcnt lgkmcnt(3)
    v_add_f32 v196, v196, v148
    v_mfma_f32_32x32x16_bf16 a[240:255], a[44:47], v[108:111], a[240:255]
    ds_write_b128 v233, a[212:215] offset:8192
    v_add_f32 v197, v197, v149
    v_add_f32 v198, v198, v150
    v_add_f32 v199, v199, v151
    s_waitcnt lgkmcnt(3)
    v_add_f32 v192, v192, v152
    v_add_f32 v193, v193, v153
    v_mfma_f32_32x32x16_bf16 a[240:255], a[52:55], v[116:119], a[240:255]
    ds_write_b128 v234, a[216:219] offset:8192
    v_add_f32 v194, v194, v154
    v_add_f32 v195, v195, v155
    s_waitcnt lgkmcnt(3)
    v_add_f32 v196, v196, v156
    v_add_f32 v197, v197, v157
    v_add_f32 v198, v198, v158
    v_add_f32 v199, v199, v159
    v_mfma_f32_32x32x16_bf16 a[240:255], a[60:63], v[124:127], a[240:255]
    ds_write_b128 v235, a[220:223] offset:8192
    v_cvt_pk_bf16_f32 v160, v192, v193
    v_cvt_pk_bf16_f32 v161, v194, v195
    v_cvt_pk_bf16_f32 v162, v196, v197
    v_cvt_pk_bf16_f32 v163, v198, v199
    buffer_store_dwordx4 v[160:163], v217, s[48:51], 0 offen sc1
    s_nop 5
    ds_write_b128 v232, a[240:243] offset:8320
    ds_write_b128 v233, a[244:247] offset:8320
    ds_write_b128 v234, a[248:251] offset:8320
    ds_write_b128 v235, a[252:255] offset:8320
    s_waitcnt lgkmcnt(0)
    s_barrier
    ds_read_b128 v[128:131], v227 offset:8192
    ds_read_b128 v[132:135], v236 offset:8192
    ds_read_b128 v[136:139], v227 offset:24576
    ds_read_b128 v[140:143], v236 offset:24576
    ds_read_b128 v[144:147], v227 offset:40960
    ds_read_b128 v[148:151], v236 offset:40960
    ds_read_b128 v[152:155], v227 offset:57344
    ds_read_b128 v[156:159], v236 offset:57344
    s_waitcnt lgkmcnt(7)
    v_pk_add_f32 v[200:201], v[200:201], v[128:129]
    v_pk_add_f32 v[202:203], v[202:203], v[130:131]
    s_waitcnt lgkmcnt(6)
    v_pk_add_f32 v[204:205], v[204:205], v[132:133]
    v_pk_add_f32 v[206:207], v[206:207], v[134:135]
    s_waitcnt lgkmcnt(5)
    v_pk_add_f32 v[200:201], v[200:201], v[136:137]
    v_pk_add_f32 v[202:203], v[202:203], v[138:139]
    s_waitcnt lgkmcnt(4)
    v_pk_add_f32 v[204:205], v[204:205], v[140:141]
    v_pk_add_f32 v[206:207], v[206:207], v[142:143]
    s_waitcnt lgkmcnt(3)
    v_pk_add_f32 v[200:201], v[200:201], v[144:145]
    v_pk_add_f32 v[202:203], v[202:203], v[146:147]
    s_waitcnt lgkmcnt(2)
    v_pk_add_f32 v[204:205], v[204:205], v[148:149]
    v_pk_add_f32 v[206:207], v[206:207], v[150:151]
    s_waitcnt lgkmcnt(1)
    v_pk_add_f32 v[200:201], v[200:201], v[152:153]
    v_pk_add_f32 v[202:203], v[202:203], v[154:155]
    s_waitcnt lgkmcnt(0)
    v_pk_add_f32 v[204:205], v[204:205], v[156:157]
    v_pk_add_f32 v[206:207], v[206:207], v[158:159]
    v_cvt_pk_bf16_f32 v164, v200, v201
    v_cvt_pk_bf16_f32 v165, v202, v203
    v_cvt_pk_bf16_f32 v166, v204, v205
    v_cvt_pk_bf16_f32 v167, v206, v207
    buffer_store_dwordx4 v[164:167], v218, s[48:51], 0 offen sc1
L_end:
    s_endpgm

L_zero:
    s_mul_i32 s73, s3, 10240
    s_add_u32 s73, s73, 12582912
    s_add_u32 s74, s73, 4096
    s_add_u32 s75, s73, 8192
    v_mov_b32 v160, 0
    v_mov_b32 v161, 0
    v_mov_b32 v162, 0
    v_mov_b32 v163, 0
    buffer_store_dwordx4 v[160:163], v52, s[52:55], s73 offen offset:0 sc1
    buffer_store_dwordx4 v[160:163], v52, s[52:55], s73 offen offset:1024 sc1
    buffer_store_dwordx4 v[160:163], v52, s[52:55], s73 offen offset:2048 sc1
    buffer_store_dwordx4 v[160:163], v52, s[52:55], s73 offen offset:3072 sc1
    buffer_store_dwordx4 v[160:163], v52, s[52:55], s74 offen offset:0 sc1
    buffer_store_dwordx4 v[160:163], v52, s[52:55], s74 offen offset:1024 sc1
    buffer_store_dwordx4 v[160:163], v52, s[52:55], s74 offen offset:2048 sc1
    buffer_store_dwordx4 v[160:163], v52, s[52:55], s74 offen offset:3072 sc1
    buffer_store_dwordx4 v[160:163], v52, s[52:55], s75 offen offset:0 sc1
    buffer_store_dwordx4 v[160:163], v52, s[52:55], s75 offen offset:1024 sc1
    s_branch L_zero_done

L_spin_init:
    s_mov_b32 s82, 200000
L_spin2_init:
    buffer_load_dword v59, v3, s[56:59], 0 offen sc1
    s_waitcnt vmcnt(0) lgkmcnt(0)
    v_cmp_eq_u32 vcc, 0, v59
    s_nop 4
    s_cbranch_vccz L_ok_init
    s_sleep 1
    s_sub_u32 s82, s82, 1
    s_cmp_lg_u32 s82, 0
    s_cbranch_scc1 L_spin2_init
    s_endpgm

L_spin_st:
    s_mov_b32 s82, 200000
L_spin2_st:
    buffer_load_dword v58, v228, s[52:55], 0 offen sc1
    s_waitcnt vmcnt(0) lgkmcnt(0)
    v_cmp_eq_u32 vcc, 0, v58
    s_nop 4
    s_cbranch_vccz L_ok_st
    s_sleep 1
    s_sub_u32 s82, s82, 1
    s_cmp_lg_u32 s82, 0
    s_cbranch_scc1 L_spin2_st
    s_endpgm

L_spin_kv:
    s_mov_b32 s82, 200000
L_spin2_kv:
    buffer_load_dword v58, v213, s[52:55], 0 offen sc1
    s_waitcnt vmcnt(0) lgkmcnt(0)
    v_cmp_eq_u32 vcc, 0, v58
    s_nop 4
    s_cbranch_vccz L_ok_kv
    s_sleep 1
    s_sub_u32 s82, s82, 1
    s_cmp_lg_u32 s82, 0
    s_cbranch_scc1 L_spin2_kv
    s_endpgm

L_spin_h:
    s_mov_b32 s82, 200000
L_spin2_h:
    buffer_load_dword v58, v214, s[52:55], 0 offen sc1
    s_waitcnt vmcnt(0) lgkmcnt(0)
    v_cmp_eq_u32 vcc, 0, v58
    s_nop 4
    s_cbranch_vccz L_ok_h
    s_sleep 1
    s_sub_u32 s82, s82, 1
    s_cmp_lg_u32 s82, 0
    s_cbranch_scc1 L_spin2_h
    s_endpgm

L_spin_h2:
    s_mov_b32 s82, 200000
L_spin2_h2:
    buffer_load_dword v58, v214, s[52:55], 0 offen sc1
    s_waitcnt vmcnt(0) lgkmcnt(0)
    v_cmp_eq_u32 vcc, 0, v58
    s_nop 4
    s_cbranch_vccz L_ok_h2
    s_sleep 1
    s_sub_u32 s82, s82, 1
    s_cmp_lg_u32 s82, 0
    s_cbranch_scc1 L_spin2_h2
    s_endpgm

L_truemax:
    s_waitcnt vmcnt(0) lgkmcnt(0)
    s_nop 15
    s_sub_i32 s73, 8, s67
    s_max_i32 s73, s73, 0
    s_mov_b32 s74, 0
L_tm_head:
    s_cmp_eq_u32 s74, 0
    s_cselect_b64 vcc, -1, 0
    s_nop 4
    v_cndmask_b32 v136, v148, v144, vcc
    v_cndmask_b32 v137, v149, v145, vcc
    v_cndmask_b32 v138, v150, v146, vcc
    v_cndmask_b32 v139, v151, v147, vcc

    v_mov_b32 v1, 0xff000000
    s_mov_b32 s76, 0
L_tm_pass:
    s_mov_b32 s75, s73
    v_mov_b32 v112, 0
    v_mov_b32 v113, 0
    v_mov_b32 v114, 0
    v_mov_b32 v115, 0
    v_mov_b32 v116, 0
    v_mov_b32 v117, 0
    v_mov_b32 v118, 0
    v_mov_b32 v119, 0
    v_mov_b32 v120, 0
    v_mov_b32 v121, 0
    v_mov_b32 v122, 0
    v_mov_b32 v123, 0
    v_mov_b32 v124, 0
    v_mov_b32 v125, 0
    v_mov_b32 v126, 0
    v_mov_b32 v127, 0

L_tm_blk:
    s_lshl_b32 s68, s75, 12
    s_lshl_b32 s69, s74, 10
    s_add_u32 s68, s68, s69
    v_add_u32 v2, s68, v208
    ds_read_b128 a[192:195], v2
    s_sub_u32 s68, 9, s75
    v_mul_lo_u32 v3, s68, v210
    v_sub_u32 v3, v209, v3
    v_add_u32 v3, s69, v3
    ds_read_b64_tr_b16 a[200:201], v3
    ds_read_b64_tr_b16 a[202:203], v3 offset:256
    ds_read_b64_tr_b16 a[204:205], v3 offset:512
    ds_read_b64_tr_b16 a[206:207], v3 offset:768
    s_waitcnt lgkmcnt(0)
    s_cmp_eq_u32 s75, 0
    s_cbranch_scc1 L_tm_far
    s_cmp_eq_u32 s75, 8
    s_cbranch_scc1 L_tm_diag
    v_mfma_f32_32x32x16_bf16 v[96:111], a[192:195], v[136:139], 0
    s_branch L_tm_s
L_tm_far:
    v_mfma_f32_32x32x16_bf16 v[96:111], a[192:195], v[136:139], v[64:79]
    s_branch L_tm_s
L_tm_diag:
    v_mfma_f32_32x32x16_bf16 v[96:111], a[192:195], v[136:139], v[80:95]
L_tm_s:
    s_nop 15
    s_cmp_eq_u32 s76, 0
    s_cbranch_scc0 L_tm_exp
    v_max_f32 v1, v1, v96
    v_max_f32 v1, v1, v97
    v_max_f32 v1, v1, v98
    v_max_f32 v1, v1, v99
    v_max_f32 v1, v1, v100
    v_max_f32 v1, v1, v101
    v_max_f32 v1, v1, v102
    v_max_f32 v1, v1, v103
    v_max_f32 v1, v1, v104
    v_max_f32 v1, v1, v105
    v_max_f32 v1, v1, v106
    v_max_f32 v1, v1, v107
    v_max_f32 v1, v1, v108
    v_max_f32 v1, v1, v109
    v_max_f32 v1, v1, v110
    v_max_f32 v1, v1, v111
    s_branch L_tm_next
L_tm_exp:
    v_sub_f32 v96, v96, v1
    v_sub_f32 v97, v97, v1
    v_sub_f32 v98, v98, v1
    v_sub_f32 v99, v99, v1
    v_sub_f32 v100, v100, v1
    v_sub_f32 v101, v101, v1
    v_sub_f32 v102, v102, v1
    v_sub_f32 v103, v103, v1
    v_sub_f32 v104, v104, v1
    v_sub_f32 v105, v105, v1
    v_sub_f32 v106, v106, v1
    v_sub_f32 v107, v107, v1
    v_sub_f32 v108, v108, v1
    v_sub_f32 v109, v109, v1
    v_sub_f32 v110, v110, v1
    v_sub_f32 v111, v111, v1
    v_exp_f32 v96, v96
    v_exp_f32 v97, v97
    v_exp_f32 v98, v98
    v_exp_f32 v99, v99
    v_exp_f32 v100, v100
    v_exp_f32 v101, v101
    v_exp_f32 v102, v102
    v_exp_f32 v103, v103
    v_exp_f32 v104, v104
    v_exp_f32 v105, v105
    v_exp_f32 v106, v106
    v_exp_f32 v107, v107
    v_exp_f32 v108, v108
    v_exp_f32 v109, v109
    v_exp_f32 v110, v110
    v_exp_f32 v111, v111
    s_nop 1
    v_cvt_pk_bf16_f32 v128, v96, v97
    v_cvt_pk_bf16_f32 v129, v98, v99
    v_cvt_pk_bf16_f32 v130, v100, v101
    v_cvt_pk_bf16_f32 v131, v102, v103
    v_cvt_pk_bf16_f32 v132, v104, v105
    v_cvt_pk_bf16_f32 v133, v106, v107
    v_cvt_pk_bf16_f32 v134, v108, v109
    v_cvt_pk_bf16_f32 v135, v110, v111

    s_nop 1
    v_mfma_f32_32x32x16_bf16 v[112:127], a[200:203], v[128:131], v[112:127]
    v_mfma_f32_32x32x16_bf16 v[112:127], a[204:207], v[132:135], v[112:127]
    s_nop 15
L_tm_next:
    s_add_u32 s75, s75, 1
    s_cmp_lt_u32 s75, 9
    s_cbranch_scc1 L_tm_blk
    s_cmp_eq_u32 s76, 0
    s_cbranch_scc0 L_tm_fin
    v_mov_b32 v2, v1
    s_nop 1
    v_permlane32_swap_b32 v1, v2
    s_nop 1
    v_max_f32 v1, v1, v2
    s_mov_b32 s76, 1
    s_branch L_tm_pass
L_tm_fin:
    s_cmp_eq_u32 s74, 0
    s_cbranch_scc0 L_tm_h1
    v_mov_b32 v160, v112
    v_mov_b32 v161, v113
    v_mov_b32 v162, v114
    v_mov_b32 v163, v115
    v_mov_b32 v164, v116
    v_mov_b32 v165, v117
    v_mov_b32 v166, v118
    v_mov_b32 v167, v119
    v_mov_b32 v168, v120
    v_mov_b32 v169, v121
    v_mov_b32 v170, v122
    v_mov_b32 v171, v123
    v_mov_b32 v172, v124
    v_mov_b32 v173, v125
    v_mov_b32 v174, v126
    v_mov_b32 v175, v127
    s_mov_b32 s74, 1
    s_branch L_tm_head
L_tm_h1:
    v_mov_b32 v176, v112
    v_mov_b32 v177, v113
    v_mov_b32 v178, v114
    v_mov_b32 v179, v115
    v_mov_b32 v180, v116
    v_mov_b32 v181, v117
    v_mov_b32 v182, v118
    v_mov_b32 v183, v119
    v_mov_b32 v184, v120
    v_mov_b32 v185, v121
    v_mov_b32 v186, v122
    v_mov_b32 v187, v123
    v_mov_b32 v188, v124
    v_mov_b32 v189, v125
    v_mov_b32 v190, v126
    v_mov_b32 v191, v127
    v_rcp_f32 v2, v168
    s_nop 0
    v_mul_f32 v160, v160, v2
    v_mul_f32 v161, v161, v2
    v_mul_f32 v162, v162, v2
    v_mul_f32 v163, v163, v2
    v_mul_f32 v164, v164, v2
    v_mul_f32 v165, v165, v2
    v_mul_f32 v166, v166, v2
    v_mul_f32 v167, v167, v2
    v_cvt_pk_bf16_f32 v172, v160, v161
    v_cvt_pk_bf16_f32 v173, v162, v163
    v_cvt_pk_bf16_f32 v174, v164, v165
    v_cvt_pk_bf16_f32 v175, v166, v167
    v_min_u32 v172, -2, v172
    s_nop 1
    s_branch L_att_done

L_spin_o0:
    s_mov_b32 s82, 200000
    s_nop 7
L_spin2_o0:
    buffer_load_dwordx4 v[64:67], v223, s[52:55], s13 offen sc1
    s_add_u32 s13, s13, 1024
    s_and_b32 s13, s13, 0x1fff
    buffer_load_dwordx4 v[72:75], v223, s[52:55], s13 offen sc1
    s_add_u32 s13, s13, 1024
    s_and_b32 s13, s13, 0x1fff
    buffer_load_dwordx4 v[80:83], v223, s[52:55], s13 offen sc1
    s_add_u32 s13, s13, 1024
    s_and_b32 s13, s13, 0x1fff
    buffer_load_dwordx4 v[88:91], v223, s[52:55], s13 offen sc1
    s_add_u32 s13, s13, 1024
    s_and_b32 s13, s13, 0x1fff
    buffer_load_dwordx4 v[96:99], v223, s[52:55], s13 offen sc1
    s_add_u32 s13, s13, 1024
    s_and_b32 s13, s13, 0x1fff
    buffer_load_dwordx4 v[104:107], v223, s[52:55], s13 offen sc1
    s_add_u32 s13, s13, 1024
    s_and_b32 s13, s13, 0x1fff
    buffer_load_dwordx4 v[112:115], v223, s[52:55], s13 offen sc1
    s_add_u32 s13, s13, 1024
    s_and_b32 s13, s13, 0x1fff
    buffer_load_dwordx4 v[120:123], v223, s[52:55], s13 offen sc1
    s_add_u32 s13, s13, 1024
    s_and_b32 s13, s13, 0x1fff
    s_waitcnt vmcnt(0) lgkmcnt(0)
    v_max3_u32 v1, v64, v72, v80
    v_max3_u32 v1, v1, v88, v96
    v_max3_u32 v1, v1, v104, v112
    v_max_u32 v1, v1, v120
    v_cmp_eq_u32 vcc, -1, v1
    s_nop 4
    s_cbranch_vccz L_ok_o0
    s_sleep 1
    s_sub_u32 s82, s82, 1
    s_cmp_lg_u32 s82, 0
    s_cbranch_scc1 L_spin2_o0
    s_endpgm

L_spin_o1:
    s_mov_b32 s82, 200000
    s_nop 7
L_spin2_o1:
    buffer_load_dwordx4 v[68:71], v224, s[52:55], s13 offen sc1
    s_add_u32 s13, s13, 1024
    s_and_b32 s13, s13, 0x1fff
    buffer_load_dwordx4 v[76:79], v224, s[52:55], s13 offen sc1
    s_add_u32 s13, s13, 1024
    s_and_b32 s13, s13, 0x1fff
    buffer_load_dwordx4 v[84:87], v224, s[52:55], s13 offen sc1
    s_add_u32 s13, s13, 1024
    s_and_b32 s13, s13, 0x1fff
    buffer_load_dwordx4 v[92:95], v224, s[52:55], s13 offen sc1
    s_add_u32 s13, s13, 1024
    s_and_b32 s13, s13, 0x1fff
    buffer_load_dwordx4 v[100:103], v224, s[52:55], s13 offen sc1
    s_add_u32 s13, s13, 1024
    s_and_b32 s13, s13, 0x1fff
    buffer_load_dwordx4 v[108:111], v224, s[52:55], s13 offen sc1
    s_add_u32 s13, s13, 1024
    s_and_b32 s13, s13, 0x1fff
    buffer_load_dwordx4 v[116:119], v224, s[52:55], s13 offen sc1
    s_add_u32 s13, s13, 1024
    s_and_b32 s13, s13, 0x1fff
    buffer_load_dwordx4 v[124:127], v224, s[52:55], s13 offen sc1
    s_add_u32 s13, s13, 1024
    s_and_b32 s13, s13, 0x1fff
    s_waitcnt vmcnt(0) lgkmcnt(0)
    v_max3_u32 v1, v68, v76, v84
    v_max3_u32 v1, v1, v92, v100
    v_max3_u32 v1, v1, v108, v116
    v_max_u32 v1, v1, v124
    v_cmp_eq_u32 vcc, -1, v1
    s_nop 4
    s_cbranch_vccz L_ok_o1
    s_sleep 1
    s_sub_u32 s82, s82, 1
    s_cmp_lg_u32 s82, 0
    s_cbranch_scc1 L_spin2_o1
    s_endpgm

L_code_end:
.fill ((parallel_sum__sliding_block__glu_gated_geglu__prompt_kernel+33024-.)/4), 4, 0xbf800000
    s_endpgm
.section .rodata,"a"
.p2align 6
.amdhsa_kernel parallel_sum__sliding_block__glu_gated_geglu__prompt_kernel
  .amdhsa_next_free_vgpr 512
  .amdhsa_next_free_sgpr 102
  .amdhsa_accum_offset 256
  .amdhsa_group_segment_fixed_size 0
  .amdhsa_kernarg_size 80
  .amdhsa_user_sgpr_count 2
  .amdhsa_user_sgpr_kernarg_segment_ptr 1
  .amdhsa_system_sgpr_workgroup_id_x 1
.end_amdhsa_kernel
```
